```python
import torch

def _softmax(x, axis=-1):
    return torch.softmax(x, dim=axis)
def _gelu(x):
    return torch.nn.functional.gelu(x, approximate="tanh")
def _silu(x):
    return torch.nn.functional.silu(x)
def _sigmoid(x):
    return torch.sigmoid(x)
def _layernorm(x, axis=-1, eps=1e-5):
    m = x.mean(dim=axis, keepdim=True)
    v = x.var(dim=axis, keepdim=True, unbiased=False)
    return (x - m) / torch.sqrt(v + eps)
def _scatter_add(tgt, idx, src, axis=0):
    return tgt.clone().index_add_(axis, idx, src)
def _segment_sum(src, seg, n):
    out = torch.zeros((n,) + src.shape[1:], dtype=src.dtype)
    return out.index_add_(0, seg, src)
def _pad(x, pw):
    flat = tuple(v for pair in reversed(pw) for v in pair)
    return torch.nn.functional.pad(x, flat)

kernel_name = 'standalone__paged_block_table_kv_pagedattention__sampling'

def setup_inputs():

    _w = (lambda a: (lambda t: t.to(torch.bfloat16) if t.is_floating_point() else t)(torch.as_tensor(a)))
    B, Hq, Hkv, Sq, Skv, D = 32, 16, 8, 1, 2048, 256
    bs = 16
    nbps = max(1, Skv // bs)
    num_phys = B * nbps + 4
    bt = torch.randperm(num_phys)[: B * nbps].reshape(B, nbps).to(torch.int64)
    cl = (nbps * bs - (torch.arange(1, B + 1, dtype=torch.int64) * 2654435761) % max(1, nbps * bs // 2)).to(torch.int64)
    return {
        "q": _w((lambda *s: torch.randn(*s, dtype=torch.bfloat16) * 0.8)(B, Hq, Sq, D)),
        "k_cache": _w((lambda *s: torch.randn(*s, dtype=torch.bfloat16) * 0.8)(num_phys, bs, Hkv, D)),
        "v_cache": _w((lambda *s: torch.randn(*s, dtype=torch.bfloat16) * 0.05)(num_phys, bs, Hkv, D)),
        "block_table": _w(bt),
        "context_lens": _w(cl),
    }

def reference(q, k_cache, v_cache, block_table, context_lens):
    B, Hq, Sq, D = q.shape
    bs = k_cache.shape[1]
    Hkv = k_cache.shape[2]
    nbps = block_table.shape[1]
    Skv = nbps * bs
    bt = block_table.reshape(-1)
    k = (lambda x, *d: x.permute(*d))(k_cache[bt].reshape(B, Skv, Hkv, D), 0, 2, 1, 3)
    v = (lambda x, *d: x.permute(*d))(v_cache[bt].reshape(B, Skv, Hkv, D), 0, 2, 1, 3)
    g = Hq // Hkv
    qg = q.reshape(B, Hkv, g, Sq, D)
    scores = torch.einsum("bhgqd,bhkd->bhgqk", qg, k) * (D ** -0.5)
    pos = torch.arange(Skv)
    msk = pos[None, :] < context_lens[:, None]
    scores = torch.where(msk[:, None, None, None, :], scores, -1e9)
    p = _softmax(scores, axis=-1)
    out = torch.einsum("bhgqk,bhkd->bhgqd", p, v)
    return out.reshape(B, Hq, Sq, D)
```

```asm
; @launch grid=(256,1,1) block=(512,1,1) lds=158784
.amdgcn_target "amdgcn-amd-amdhsa--gfx950"
.text
.globl standalone__paged_block_table_kv_pagedattention__sampling_kernel
.p2align 8
.type standalone__paged_block_table_kv_pagedattention__sampling_kernel,@function
standalone__paged_block_table_kv_pagedattention__sampling_kernel:
    s_cmp_ge_u32 s2, 256
    s_cbranch_scc1 L_end
    s_load_dwordx16 s[36:51], s[0:1], 0
    v_lshrrev_b32 v20, 6, v0
    v_and_b32 v0, 63, v0
    v_readfirstlane_b32 s52, v20
    v_lshrrev_b32 v20, 5, v0
    v_and_b32 v21, 31, v0
    v_lshlrev_b32 v22, 4, v21
    v_lshl_add_u32 v1, v20, 15, v22
    v_lshl_add_u32 v32, v20, 9, v22
    v_lshl_add_u32 v6, v20, 10, v22
    v_and_b32 v22, 15, v0
    v_lshlrev_b32 v22, 9, v22
    v_lshl_add_u32 v33, v20, 3, v22
    v_lshlrev_b32 v4, 4, v0
    v_lshlrev_b32 v7, 2, v0
    v_lshrrev_b32 v20, 4, v0
    v_lshlrev_b32 v5, 2, v20
    v_lshlrev_b32 v22, 4, v20
    v_bfe_u32 v21, v0, 3, 1
    v_lshl_add_u32 v23, v21, 9, v22
    v_and_b32 v21, 7, v0
    v_mul_u32_u24 v21, 1056, v21
    s_mul_i32 s83, s52, 8448
    s_add_u32 s83, s83, 16384
    s_lshl_b32 s84, s52, 10
    s_add_u32 s84, s84, 83968
    v_add3_u32 v2, v23, v21, s83
    v_and_b32 v21, 1, v0
    v_lshl_add_u32 v22, v21, 9, v22
    v_add_u32 v3, s84, v22
    v_mov_b32 v19, 0xff800000
    s_mov_b32 s86, 0x05040100
    s_mov_b32 s87, 0x07060302
    s_lshr_b32 s53, s2, 3
    s_and_b32 s54, s2, 7
    s_lshl_b32 s85, s54, 9
    s_and_b32 s56, s54, 1
    s_lshl_b32 s56, s56, 5
    s_add_u32 s56, s56, s53
    s_lshl_b32 s75, s53, 7
    s_add_u32 s75, s75, s52
    s_lshl_b32 s75, s75, 2
    s_mov_b32 s69, 0
    s_mov_b32 s68, 0
    s_mov_b32 s73, 0
    s_mov_b32 s66, 0
    s_mov_b32 s91, 0
    s_mov_b32 s92, 0
    v_mov_b32 v39, 92160
    v_and_b32 v23, 124, v7
    v_add_u32 v20, -4, v0
    v_max_i32 v20, 0, v20
    v_lshlrev_b32 v20, 16, v20
    v_add_u32 v21, 92160, v7
    s_lshl_b32 s74, s52, 11
    s_mov_b64 exec, 0xff
    ds_write_b32 v21, v20
    s_mov_b64 exec, -1
    s_waitcnt lgkmcnt(0)
    s_load_dword s62, s[42:43], s75
    s_mov_b32 s32, s44
    s_and_b32 s33, s45, 0xffff
    s_mov_b32 s34, 128
    s_mov_b32 s35, 0x20000
    s_mov_b32 s28, s42
    s_and_b32 s29, s43, 0xffff
    s_mov_b32 s30, 16384
    s_mov_b32 s31, 0x20000
    buffer_load_dword v9, v23, s[32:35], 0 offen
    s_mov_b32 m0, s74
    s_mov_b32 s4, s38
    s_and_b32 s5, s39, 0xffff
    s_mov_b32 s6, 268697600
    s_mov_b32 s7, 0x20000
    buffer_load_dwordx4 v4, s[28:31], s74 offen lds
    buffer_load_dwordx4 v4, s[28:31], s74 offen offset:1024 lds
    s_mov_b32 s12, s36
    s_and_b32 s13, s37, 0xffff
    s_mov_b32 s14, 262144
    s_mov_b32 s15, 0x20000
    s_mov_b32 s8, s40
    s_and_b32 s9, s41, 0xffff
    s_mov_b32 s10, 268697600
    s_mov_b32 s11, 0x20000
    s_mov_b32 s16, s50
    s_and_b32 s17, s51, 0xffff
    s_mov_b32 s18, 1074790400
    s_mov_b32 s19, 0x20000
    s_mov_b32 s20, s48
    s_and_b32 s21, s49, 0xffff
    s_mov_b32 s22, 256
    s_mov_b32 s23, 0x20000
    s_mov_b32 s24, s46
    s_and_b32 s25, s47, 0xffff
    s_mov_b32 s26, 262144
    s_mov_b32 s27, 0x20000
    s_mov_b32 s63, s56
    s_mov_b32 s64, s52
    s_mov_b32 s65, 0
    s_mov_b32 s93, 268697600
    s_lshl_b32 s75, s85, 1
    s_and_b32 s76, s63, 31
    s_lshl_b32 s76, s76, 13
    s_mov_b32 m0, s84
    s_add_u32 s75, s75, s76
    buffer_load_dwordx4 v4, s[12:15], s75 offen lds
    s_waitcnt lgkmcnt(0)
    s_lshl_b32 s62, s62, 16
    s_add_u32 s62, s62, s85
    s_mov_b32 m0, s83
    s_mov_b32 s6, s93
    s_mov_b32 s77, s62
    buffer_load_dwordx4 v1, s[4:7], s77 offen nt lds
    s_add_u32 m0, m0, 1056
    s_add_u32 s77, s77, 4096
    buffer_load_dwordx4 v1, s[4:7], s77 offen nt lds
    s_add_u32 m0, m0, 1056
    s_add_u32 s77, s77, 4096
    buffer_load_dwordx4 v1, s[4:7], s77 offen nt lds
    s_add_u32 m0, m0, 1056
    s_add_u32 s77, s77, 4096
    buffer_load_dwordx4 v1, s[4:7], s77 offen nt lds
    s_add_u32 m0, m0, 1056
    s_add_u32 s77, s77, 4096
    buffer_load_dwordx4 v1, s[4:7], s77 offen nt lds
    s_add_u32 m0, m0, 1056
    s_add_u32 s77, s77, 4096
    buffer_load_dwordx4 v1, s[4:7], s77 offen nt lds
    s_add_u32 m0, m0, 1056
    s_add_u32 s77, s77, 4096
    buffer_load_dwordx4 v1, s[4:7], s77 offen nt lds
    s_add_u32 m0, m0, 1056
    s_add_u32 s77, s77, 4096
    buffer_load_dwordx4 v1, s[4:7], s77 offen nt lds
    v_mov_b32 v21, 2048
    v_mov_b32 v22, 0x3db8aa3b
    s_waitcnt vmcnt(11)
    v_add_u32 v20, -1, v9
    v_cmp_gt_u32 vcc, v21, v20
    v_cmp_ge_i32 s[76:77], 0, v9
    s_nop 0
    v_cndmask_b32 v9, v21, v9, vcc
    v_cndmask_b32 v10, v22, 0, s[76:77]
    v_add_u32 v8, 15, v9
    v_lshrrev_b32 v8, 4, v8
    v_mov_b32 v20, v8
    s_nop 1
    v_add_u32_dpp v20, v20, v20 row_shr:1 row_mask:0xf bank_mask:0xf bound_ctrl:0
    s_nop 1
    v_add_u32_dpp v20, v20, v20 row_shr:2 row_mask:0xf bank_mask:0xf bound_ctrl:0
    s_nop 1
    v_add_u32_dpp v20, v20, v20 row_shr:4 row_mask:0xf bank_mask:0xf bound_ctrl:0
    s_nop 1
    v_add_u32_dpp v20, v20, v20 row_shr:8 row_mask:0xf bank_mask:0xf bound_ctrl:0
    s_nop 1
    v_add_u32_dpp v20, v20, v20 row_bcast:15 row_mask:0xa bank_mask:0xf
    v_cmp_gt_u32 vcc, 32, v0
    v_readlane_b32 s74, v20, 31
    s_add_u32 s74, s74, 31
    s_lshr_b32 s74, s74, 5
    s_sub_u32 s75, s74, 1
    s_min_u32 s75, s75, 5
    s_add_u32 s76, s74, s75
    s_sub_u32 s75, s74, s75
    v_mov_b32 v22, s75
    v_mov_b32 v23, s76
    v_cndmask_b32 v22, v22, v23, vcc
    v_min_u32 v21, v22, v8
    v_sub_u32 v11, v8, v21
    v_sub_u32 v13, v22, v21
    v_lshl_or_b32 v20, v13, 16, v11
    v_cmp_ne_u32 s[78:79], 0, v11
    v_cmp_ne_u32 s[80:81], 0, v13
    s_nop 1
    v_add_u32_dpp v20, v20, v20 row_shr:1 row_mask:0xf bank_mask:0xf bound_ctrl:0
    s_nop 1
    v_add_u32_dpp v20, v20, v20 row_shr:2 row_mask:0xf bank_mask:0xf bound_ctrl:0
    s_nop 1
    v_add_u32_dpp v20, v20, v20 row_shr:4 row_mask:0xf bank_mask:0xf bound_ctrl:0
    s_nop 1
    v_add_u32_dpp v20, v20, v20 row_shr:8 row_mask:0xf bank_mask:0xf bound_ctrl:0
    s_nop 1
    v_add_u32_dpp v20, v20, v20 row_bcast:15 row_mask:0xa bank_mask:0xf
    s_nop 1
    v_add_u32_dpp v20, v20, v20 row_bcast:31 row_mask:0xc bank_mask:0xf
    s_waitcnt vmcnt(9)
    s_barrier
    v_readlane_b32 s31, v21, s56
    v_readlane_b32 s88, v13, s56
    v_and_b32 v12, 0xffff, v20
    v_lshrrev_b32 v14, 16, v20
    s_bfm_b64 s[74:75], s56, 0
    s_and_b64 s[74:75], s[74:75], s[80:81]
    s_bcnt1_i32_b64 s34, s[74:75]
    v_readlane_b32 s77, v12, 63
    v_readlane_b32 s29, v14, s56
    v_readlane_b32 s32, v11, s56
    s_sub_u32 s28, s29, s88
    s_min_u32 s28, s28, s77
    s_min_u32 s29, s29, s77
    s_sub_u32 s30, s29, s28
    v_cmp_ge_u32 vcc, s28, v12
    s_and_b64 s[74:75], vcc, s[78:79]
    s_bcnt1_i32_b64 s35, s[74:75]
    v_readlane_b32 s74, v12, s56
    v_readlane_b32 s88, v11, s56
    s_sub_u32 s88, s74, s88
    s_sub_u32 s74, s74, 1
    v_cmp_ge_u32 vcc, s74, v14
    s_and_b64 s[76:77], vcc, s[80:81]
    s_bcnt1_i32_b64 s82, s[76:77]
    v_cmp_ge_u32 vcc, s88, v14
    s_and_b64 s[76:77], vcc, s[80:81]
    s_bcnt1_i32_b64 s33, s[76:77]
    s_sub_u32 s82, s82, s33
    s_add_u32 s82, s82, 1
    s_add_u32 s33, s33, s56
    v_readlane_b32 s74, v9, s56
    s_lshl_b32 s75, s52, 4
    s_sub_u32 s74, s74, s75
    s_lshl_b32 s75, s74, 12
    s_sub_u32 s76, s62, s85
    s_add_u32 s75, s75, s76
    s_cmp_lt_u32 s74, 16
    s_cselect_b32 s93, s75, 268697600
    s_sub_u32 s72, s31, 24
    s_max_i32 s72, s72, 0
    s_add_u32 s72, s72, s30
    s_cmp_eq_u32 s32, 0
    s_cselect_b32 s82, 0, s82
    s_cselect_b32 s71, 3, 0
    s_cselect_b32 s72, 0xffff, s72
    s_lshl_b32 s74, s52, 8
    v_add_u32 v178, s74, v7
    v_mov_b32 v136, 0
    v_mov_b32 v137, 0
    v_mov_b32 v138, 0
    v_mov_b32 v139, 0
    v_mov_b32 v140, 0
    v_mov_b32 v141, 0
    v_mov_b32 v142, 0
    v_mov_b32 v143, 0
    v_mov_b32 v144, 0
    v_mov_b32 v145, 0
    v_mov_b32 v146, 0
    v_mov_b32 v147, 0
    v_mov_b32 v148, 0
    v_mov_b32 v149, 0
    v_mov_b32 v150, 0
    v_mov_b32 v151, 0
    v_mov_b32 v152, 0
    v_mov_b32 v153, 0
    v_mov_b32 v154, 0
    v_mov_b32 v155, 0
    v_mov_b32 v156, 0
    v_mov_b32 v157, 0
    v_mov_b32 v158, 0
    v_mov_b32 v159, 0
    v_mov_b32 v160, 0
    v_mov_b32 v161, 0
    v_mov_b32 v162, 0
    v_mov_b32 v163, 0
    v_mov_b32 v164, 0
    v_mov_b32 v165, 0
    v_mov_b32 v166, 0
    v_mov_b32 v167, 0
    v_mov_b32 v17, 0xf149f2ca
    v_mov_b32 v18, 0
    v_mov_b32 v36, 0
    v_mov_b32 v16, 0
    s_cmp_lt_u32 s52, s31
    s_cbranch_scc1 L_newseg
    v_mov_b32 v20, 1
    s_mov_b64 exec, 1
    ds_add_rtn_u32 v30, v39, v20
    s_mov_b64 exec, -1
    s_waitcnt vmcnt(0) lgkmcnt(0)
    v_readfirstlane_b32 s75, v30
    s_and_b32 s74, s75, 0xffff
    s_lshr_b32 s75, s75, 16
    s_or_b32 s71, s71, s75
    s_cmp_eq_u32 s74, s72
    s_cselect_b32 s73, 2, s73
    s_cmp_ge_u32 s74, s30
    s_cbranch_scc1 L_dn_own1
    s_add_u32 s74, s74, s28
    v_cmp_ge_u32 vcc, s74, v12
    s_bcnt1_i32_b64 s63, vcc
    v_readlane_b32 s76, v12, s63
    v_readlane_b32 s75, v8, s63
    s_sub_u32 s76, s76, s74
    s_sub_u32 s64, s75, s76
    s_mov_b32 s65, 1
    s_branch L_dn_bt1
L_dn_own1:
    s_sub_u32 s74, s74, s30
    s_add_u32 s64, s74, 8
    s_mov_b32 s63, s56
    s_cmp_lt_u32 s64, s31
    s_cselect_b32 s65, 0, 2
    s_cselect_b32 s64, s64, 0
L_dn_bt1:
    s_and_b32 s74, s63, 31
    s_lshl_b32 s74, s74, 7
    s_add_u32 s74, s74, s64
    s_lshl_b32 s74, s74, 2
    v_mov_b32 v20, s74
    v_readlane_b32 s93, v9, s63
    s_lshr_b32 s85, s63, 5
    s_and_b32 s75, s54, 6
    s_or_b32 s85, s85, s75
    s_lshl_b32 s85, s85, 9
    s_lshl_b32 s75, s64, 4
    s_sub_u32 s93, s93, s75
    ds_read_b32 v38, v20
    s_lshl_b32 s75, s85, 1
    s_and_b32 s76, s63, 31
    s_lshl_b32 s76, s76, 13
    s_mov_b32 m0, s84
    s_add_u32 s75, s75, s76
    buffer_load_dwordx4 v4, s[12:15], s75 offen lds
    s_waitcnt lgkmcnt(0)
    v_readfirstlane_b32 s62, v38
    s_lshl_b32 s62, s62, 16
    s_lshl_b32 s74, s93, 12
    s_add_u32 s74, s74, s62
    s_cmp_lt_u32 s93, 16
    s_cselect_b32 s93, s74, 268697600
    s_add_u32 s62, s62, s85
    s_cmp_eq_u32 s65, 2
    s_cselect_b32 s62, 536870912, s62
    s_mov_b32 m0, s83
    s_mov_b32 s6, s93
    s_mov_b32 s77, s62
    buffer_load_dwordx4 v1, s[4:7], s77 offen nt lds
    s_add_u32 m0, m0, 1056
    s_add_u32 s77, s77, 4096
    buffer_load_dwordx4 v1, s[4:7], s77 offen nt lds
    s_add_u32 m0, m0, 1056
    s_add_u32 s77, s77, 4096
    buffer_load_dwordx4 v1, s[4:7], s77 offen nt lds
    s_add_u32 m0, m0, 1056
    s_add_u32 s77, s77, 4096
    buffer_load_dwordx4 v1, s[4:7], s77 offen nt lds
    s_add_u32 m0, m0, 1056
    s_add_u32 s77, s77, 4096
    buffer_load_dwordx4 v1, s[4:7], s77 offen nt lds
    s_add_u32 m0, m0, 1056
    s_add_u32 s77, s77, 4096
    buffer_load_dwordx4 v1, s[4:7], s77 offen nt lds
    s_add_u32 m0, m0, 1056
    s_add_u32 s77, s77, 4096
    buffer_load_dwordx4 v1, s[4:7], s77 offen nt lds
    s_add_u32 m0, m0, 1056
    s_add_u32 s77, s77, 4096
    buffer_load_dwordx4 v1, s[4:7], s77 offen nt lds
    s_cmp_eq_u32 s65, 2
    s_cbranch_scc1 L_own_done
    s_branch L_newseg
L_deposit:
    v_mov_b32 v20, v18
    v_mov_b32 v21, v17
    v_mov_b32 v22, v17
    s_nop 0
    v_permlane16_swap_b32 v18, v20
    v_permlane32_swap_b32 v21, v22
    v_add_f32 v18, v18, v20
    v_max_f32 v31, v21, v22
    v_sub_f32 v22, v17, v31
    v_mul_f32 v22, s61, v22
    v_exp_f32 v22, v22
    v_mul_f32 v34, s61, v31
    s_nop 0
    v_mul_f32 v18, v18, v22
    v_mul_f32_dpp v136, v22, v136 quad_perm:[0,0,2,2] row_mask:0xf bank_mask:0xf
    v_mul_f32_dpp v137, v22, v137 quad_perm:[1,1,3,3] row_mask:0xf bank_mask:0xf
    v_mul_f32_dpp v140, v22, v140 quad_perm:[0,0,2,2] row_mask:0xf bank_mask:0xf
    v_mul_f32_dpp v141, v22, v141 quad_perm:[1,1,3,3] row_mask:0xf bank_mask:0xf
    v_mul_f32_dpp v144, v22, v144 quad_perm:[0,0,2,2] row_mask:0xf bank_mask:0xf
    v_mul_f32_dpp v145, v22, v145 quad_perm:[1,1,3,3] row_mask:0xf bank_mask:0xf
    v_mul_f32_dpp v148, v22, v148 quad_perm:[0,0,2,2] row_mask:0xf bank_mask:0xf
    v_mul_f32_dpp v149, v22, v149 quad_perm:[1,1,3,3] row_mask:0xf bank_mask:0xf
    v_mul_f32_dpp v152, v22, v152 quad_perm:[0,0,2,2] row_mask:0xf bank_mask:0xf
    v_mul_f32_dpp v153, v22, v153 quad_perm:[1,1,3,3] row_mask:0xf bank_mask:0xf
    v_mul_f32_dpp v156, v22, v156 quad_perm:[0,0,2,2] row_mask:0xf bank_mask:0xf
    v_mul_f32_dpp v157, v22, v157 quad_perm:[1,1,3,3] row_mask:0xf bank_mask:0xf
    v_mul_f32_dpp v160, v22, v160 quad_perm:[0,0,2,2] row_mask:0xf bank_mask:0xf
    v_mul_f32_dpp v161, v22, v161 quad_perm:[1,1,3,3] row_mask:0xf bank_mask:0xf
    v_mul_f32_dpp v164, v22, v164 quad_perm:[0,0,2,2] row_mask:0xf bank_mask:0xf
    v_mul_f32_dpp v165, v22, v165 quad_perm:[1,1,3,3] row_mask:0xf bank_mask:0xf
    v_mov_b32 v20, v18
    s_nop 1
    v_permlane32_swap_b32 v18, v20
    v_permlane32_swap_b32 v136, v137
    v_permlane32_swap_b32 v140, v141
    v_permlane32_swap_b32 v144, v145
    v_permlane32_swap_b32 v148, v149
    v_permlane32_swap_b32 v152, v153
    v_permlane32_swap_b32 v156, v157
    v_permlane32_swap_b32 v160, v161
    v_permlane32_swap_b32 v164, v165
    v_add_f32 v35, v18, v20
    v_add_f32 v72, v136, v137
    v_add_f32 v73, v140, v141
    v_add_f32 v74, v144, v145
    v_add_f32 v75, v148, v149
    v_add_f32 v76, v152, v153
    v_add_f32 v77, v156, v157
    v_add_f32 v78, v160, v161
    v_add_f32 v79, v164, v165
    v_lshlrev_b32 v20, 3, v0
    s_bfm_b64 s[74:75], s58, 0
    s_and_b64 s[74:75], s[74:75], s[78:79]
    s_bcnt1_i32_b64 s74, s[74:75]
    s_sub_u32 s88, s74, s35
    s_and_b32 s74, s88, 3
    s_lshl_b32 s75, s74, 2
    s_add_u32 s75, s75, 92176
    v_mov_b32 v23, s75
    s_mul_i32 s90, s74, 16640
    s_add_u32 s90, s90, 92224
L_gen:
    ds_read_b32 v22, v23
    s_waitcnt lgkmcnt(0)
    v_readfirstlane_b32 s74, v22
    s_lshr_b32 s74, s74, 16
    s_cmp_lg_u32 s74, s88
    s_cbranch_scc1 L_gen
    s_mul_i32 s74, s52, 2080
    s_add_u32 s74, s74, s90
    v_add_u32 v21, s74, v6
    v_add_u32 v20, s74, v20
    ds_write_b128 v21, v[72:75]
    ds_write_b128 v21, v[76:79] offset:512
    s_mov_b64 exec, 3
    ds_write_b64 v20, v[34:35] offset:2048
    s_mov_b64 exec, -1
    s_lshl_b32 s74, 0x100, s52
    s_add_u32 s74, s74, s66
    v_mov_b32 v22, s74
    v_readlane_b32 s75, v12, s58
    v_readlane_b32 s76, v11, s58
    s_waitcnt lgkmcnt(0)
    s_mov_b64 exec, 1
    ds_add_rtn_u32 v21, v23, v22
    s_mov_b64 exec, -1
    s_sub_u32 s76, s75, s76
    s_max_u32 s76, s76, s28
    s_min_u32 s75, s75, s29
    s_sub_u32 s75, s75, s76
    s_mov_b32 s66, 0
    s_waitcnt lgkmcnt(0)
    v_readfirstlane_b32 s76, v21
    s_add_u32 s74, s74, s76
    s_and_b32 s76, s74, 0xff
    s_cmp_lg_u32 s76, s75
    s_cbranch_scc1 L_deposited
    s_mov_b32 s68, s75
    s_mov_b32 s67, s58
    s_bfe_u32 s74, s74, 0x80008
    v_and_b32 v20, 7, v0
    v_mul_u32_u24 v20, 2080, v20
    v_lshrrev_b32 v21, 5, v0
    v_lshl_add_u32 v20, v21, 3, v20
    v_add_u32 v20, s90, v20
    v_add_u32 v21, s90, v6
    ds_read_b64 v[182:183], v20 offset:2048
    ds_read_b128 v[72:75], v21 offset:0
    ds_read_b128 v[76:79], v21 offset:512
    ds_read_b128 v[80:83], v21 offset:2080
    ds_read_b128 v[84:87], v21 offset:2592
    ds_read_b128 v[88:91], v21 offset:4160
    ds_read_b128 v[92:95], v21 offset:4672
    ds_read_b128 v[96:99], v21 offset:6240
    ds_read_b128 v[100:103], v21 offset:6752
    ds_read_b128 v[104:107], v21 offset:8320
    ds_read_b128 v[108:111], v21 offset:8832
    ds_read_b128 v[112:115], v21 offset:10400
    ds_read_b128 v[116:119], v21 offset:10912
    ds_read_b128 v[120:123], v21 offset:12480
    ds_read_b128 v[124:127], v21 offset:12992
    ds_read_b128 v[128:131], v21 offset:14560
    ds_read_b128 v[132:135], v21 offset:15072
    v_and_b32 v20, 15, v0
    v_lshrrev_b32 v20, v20, s74
    v_and_b32 v20, 1, v20
    v_cmp_ne_u32 vcc, 0, v20
    s_add_u32 s75, s88, 4
    s_lshl_b32 s75, s75, 16
    v_mov_b32 v22, s75
    s_waitcnt lgkmcnt(0)
    ds_write_b32 v23, v22
    v_cndmask_b32 v182, v19, v182, vcc
    v_cndmask_b32 v183, 0, v183, vcc
    v_mov_b32 v24, v182
    s_nop 1
    v_max_f32_dpp v24, v24, v24 row_ror:1 row_mask:0xf bank_mask:0xf
    s_nop 1
    v_max_f32_dpp v24, v24, v24 row_ror:2 row_mask:0xf bank_mask:0xf
    s_nop 1
    v_max_f32_dpp v24, v24, v24 row_ror:4 row_mask:0xf bank_mask:0xf
    s_nop 1
    v_max_f32_dpp v24, v24, v24 row_ror:8 row_mask:0xf bank_mask:0xf
    v_sub_f32 v179, v182, v24
    v_exp_f32 v179, v179
    v_mov_b32 v136, 0
    v_mov_b32 v137, 0
    v_mov_b32 v138, 0
    v_mov_b32 v139, 0
    v_mov_b32 v140, 0
    v_mov_b32 v141, 0
    v_mov_b32 v142, 0
    v_mov_b32 v143, 0
    v_mul_f32 v25, v179, v183
    s_nop 1
    v_add_f32_dpp v25, v25, v25 row_ror:1 row_mask:0xf bank_mask:0xf
    s_nop 1
    v_add_f32_dpp v25, v25, v25 row_ror:2 row_mask:0xf bank_mask:0xf
    s_nop 1
    v_add_f32_dpp v25, v25, v25 row_ror:4 row_mask:0xf bank_mask:0xf
    s_nop 1
    v_add_f32_dpp v25, v25, v25 row_ror:8 row_mask:0xf bank_mask:0xf
    s_bitcmp0_b32 s74, 0
    s_cbranch_scc1 L_mskip0
    v_fmac_f32_dpp v136, v179, v72 row_newbcast:0 row_mask:0xf bank_mask:0xf
    v_fmac_f32_dpp v137, v179, v73 row_newbcast:0 row_mask:0xf bank_mask:0xf
    v_fmac_f32_dpp v138, v179, v74 row_newbcast:0 row_mask:0xf bank_mask:0xf
    v_fmac_f32_dpp v139, v179, v75 row_newbcast:0 row_mask:0xf bank_mask:0xf
    v_fmac_f32_dpp v140, v179, v76 row_newbcast:0 row_mask:0xf bank_mask:0xf
    v_fmac_f32_dpp v141, v179, v77 row_newbcast:0 row_mask:0xf bank_mask:0xf
    v_fmac_f32_dpp v142, v179, v78 row_newbcast:0 row_mask:0xf bank_mask:0xf
    v_fmac_f32_dpp v143, v179, v79 row_newbcast:0 row_mask:0xf bank_mask:0xf
L_mskip0:
    s_bitcmp0_b32 s74, 1
    s_cbranch_scc1 L_mskip1
    v_fmac_f32_dpp v136, v179, v80 row_newbcast:1 row_mask:0xf bank_mask:0xf
    v_fmac_f32_dpp v137, v179, v81 row_newbcast:1 row_mask:0xf bank_mask:0xf
    v_fmac_f32_dpp v138, v179, v82 row_newbcast:1 row_mask:0xf bank_mask:0xf
    v_fmac_f32_dpp v139, v179, v83 row_newbcast:1 row_mask:0xf bank_mask:0xf
    v_fmac_f32_dpp v140, v179, v84 row_newbcast:1 row_mask:0xf bank_mask:0xf
    v_fmac_f32_dpp v141, v179, v85 row_newbcast:1 row_mask:0xf bank_mask:0xf
    v_fmac_f32_dpp v142, v179, v86 row_newbcast:1 row_mask:0xf bank_mask:0xf
    v_fmac_f32_dpp v143, v179, v87 row_newbcast:1 row_mask:0xf bank_mask:0xf
L_mskip1:
    s_bitcmp0_b32 s74, 2
    s_cbranch_scc1 L_mskip2
    v_fmac_f32_dpp v136, v179, v88 row_newbcast:2 row_mask:0xf bank_mask:0xf
    v_fmac_f32_dpp v137, v179, v89 row_newbcast:2 row_mask:0xf bank_mask:0xf
    v_fmac_f32_dpp v138, v179, v90 row_newbcast:2 row_mask:0xf bank_mask:0xf
    v_fmac_f32_dpp v139, v179, v91 row_newbcast:2 row_mask:0xf bank_mask:0xf
    v_fmac_f32_dpp v140, v179, v92 row_newbcast:2 row_mask:0xf bank_mask:0xf
    v_fmac_f32_dpp v141, v179, v93 row_newbcast:2 row_mask:0xf bank_mask:0xf
    v_fmac_f32_dpp v142, v179, v94 row_newbcast:2 row_mask:0xf bank_mask:0xf
    v_fmac_f32_dpp v143, v179, v95 row_newbcast:2 row_mask:0xf bank_mask:0xf
L_mskip2:
    s_bitcmp0_b32 s74, 3
    s_cbranch_scc1 L_mskip3
    v_fmac_f32_dpp v136, v179, v96 row_newbcast:3 row_mask:0xf bank_mask:0xf
    v_fmac_f32_dpp v137, v179, v97 row_newbcast:3 row_mask:0xf bank_mask:0xf
    v_fmac_f32_dpp v138, v179, v98 row_newbcast:3 row_mask:0xf bank_mask:0xf
    v_fmac_f32_dpp v139, v179, v99 row_newbcast:3 row_mask:0xf bank_mask:0xf
    v_fmac_f32_dpp v140, v179, v100 row_newbcast:3 row_mask:0xf bank_mask:0xf
    v_fmac_f32_dpp v141, v179, v101 row_newbcast:3 row_mask:0xf bank_mask:0xf
    v_fmac_f32_dpp v142, v179, v102 row_newbcast:3 row_mask:0xf bank_mask:0xf
    v_fmac_f32_dpp v143, v179, v103 row_newbcast:3 row_mask:0xf bank_mask:0xf
L_mskip3:
    s_bitcmp0_b32 s74, 4
    s_cbranch_scc1 L_mskip4
    v_fmac_f32_dpp v136, v179, v104 row_newbcast:4 row_mask:0xf bank_mask:0xf
    v_fmac_f32_dpp v137, v179, v105 row_newbcast:4 row_mask:0xf bank_mask:0xf
    v_fmac_f32_dpp v138, v179, v106 row_newbcast:4 row_mask:0xf bank_mask:0xf
    v_fmac_f32_dpp v139, v179, v107 row_newbcast:4 row_mask:0xf bank_mask:0xf
    v_fmac_f32_dpp v140, v179, v108 row_newbcast:4 row_mask:0xf bank_mask:0xf
    v_fmac_f32_dpp v141, v179, v109 row_newbcast:4 row_mask:0xf bank_mask:0xf
    v_fmac_f32_dpp v142, v179, v110 row_newbcast:4 row_mask:0xf bank_mask:0xf
    v_fmac_f32_dpp v143, v179, v111 row_newbcast:4 row_mask:0xf bank_mask:0xf
L_mskip4:
    s_bitcmp0_b32 s74, 5
    s_cbranch_scc1 L_mskip5
    v_fmac_f32_dpp v136, v179, v112 row_newbcast:5 row_mask:0xf bank_mask:0xf
    v_fmac_f32_dpp v137, v179, v113 row_newbcast:5 row_mask:0xf bank_mask:0xf
    v_fmac_f32_dpp v138, v179, v114 row_newbcast:5 row_mask:0xf bank_mask:0xf
    v_fmac_f32_dpp v139, v179, v115 row_newbcast:5 row_mask:0xf bank_mask:0xf
    v_fmac_f32_dpp v140, v179, v116 row_newbcast:5 row_mask:0xf bank_mask:0xf
    v_fmac_f32_dpp v141, v179, v117 row_newbcast:5 row_mask:0xf bank_mask:0xf
    v_fmac_f32_dpp v142, v179, v118 row_newbcast:5 row_mask:0xf bank_mask:0xf
    v_fmac_f32_dpp v143, v179, v119 row_newbcast:5 row_mask:0xf bank_mask:0xf
L_mskip5:
    s_bitcmp0_b32 s74, 6
    s_cbranch_scc1 L_mskip6
    v_fmac_f32_dpp v136, v179, v120 row_newbcast:6 row_mask:0xf bank_mask:0xf
    v_fmac_f32_dpp v137, v179, v121 row_newbcast:6 row_mask:0xf bank_mask:0xf
    v_fmac_f32_dpp v138, v179, v122 row_newbcast:6 row_mask:0xf bank_mask:0xf
    v_fmac_f32_dpp v139, v179, v123 row_newbcast:6 row_mask:0xf bank_mask:0xf
    v_fmac_f32_dpp v140, v179, v124 row_newbcast:6 row_mask:0xf bank_mask:0xf
    v_fmac_f32_dpp v141, v179, v125 row_newbcast:6 row_mask:0xf bank_mask:0xf
    v_fmac_f32_dpp v142, v179, v126 row_newbcast:6 row_mask:0xf bank_mask:0xf
    v_fmac_f32_dpp v143, v179, v127 row_newbcast:6 row_mask:0xf bank_mask:0xf
L_mskip6:
    s_bitcmp0_b32 s74, 7
    s_cbranch_scc1 L_mskip7
    v_fmac_f32_dpp v136, v179, v128 row_newbcast:7 row_mask:0xf bank_mask:0xf
    v_fmac_f32_dpp v137, v179, v129 row_newbcast:7 row_mask:0xf bank_mask:0xf
    v_fmac_f32_dpp v138, v179, v130 row_newbcast:7 row_mask:0xf bank_mask:0xf
    v_fmac_f32_dpp v139, v179, v131 row_newbcast:7 row_mask:0xf bank_mask:0xf
    v_fmac_f32_dpp v140, v179, v132 row_newbcast:7 row_mask:0xf bank_mask:0xf
    v_fmac_f32_dpp v141, v179, v133 row_newbcast:7 row_mask:0xf bank_mask:0xf
    v_fmac_f32_dpp v142, v179, v134 row_newbcast:7 row_mask:0xf bank_mask:0xf
    v_fmac_f32_dpp v143, v179, v135 row_newbcast:7 row_mask:0xf bank_mask:0xf
L_mskip7:
    v_readlane_b32 s76, v24, 32
    v_readlane_b32 s77, v25, 32
    s_add_u32 s90, s34, s58
    s_lshl_b32 s74, s90, 2
    s_lshr_b32 s75, s54, 1
    s_add_u32 s74, s74, s75
    s_lshl_b32 s75, s74, 11
    s_lshl_b32 s74, s74, 7
    s_add_u32 s74, s74, 8388608
    v_mov_b32 v26, s76
    v_mov_b32 v27, s77
    buffer_store_dwordx4 v[136:139], v6, s[16:19], s75 offen sc1
    buffer_store_dwordx4 v[140:143], v6, s[16:19], s75 offen offset:512 sc1
    s_mov_b64 exec, 0xff
    buffer_store_dwordx4 v[24:27], v4, s[16:19], s74 offen sc1
    s_mov_b64 exec, -1
    s_add_u32 s91, s91, 3
    s_nop 0
L_deposited:
    s_cmp_eq_u32 s65, 1
    s_cbranch_scc1 L_fresh
    s_cmp_eq_u32 s92, 0
    s_cbranch_scc1 L_fresh
    v_mov_b32 v136, v184
    v_mov_b32 v137, v185
    v_mov_b32 v140, v186
    v_mov_b32 v141, v187
    v_mov_b32 v144, v188
    v_mov_b32 v145, v189
    v_mov_b32 v148, v190
    v_mov_b32 v149, v191
    v_mov_b32 v152, v192
    v_mov_b32 v153, v193
    v_mov_b32 v156, v194
    v_mov_b32 v157, v195
    v_mov_b32 v160, v196
    v_mov_b32 v161, v197
    v_mov_b32 v164, v198
    v_mov_b32 v165, v199
    v_mov_b32 v17, v200
    v_mov_b32 v18, v201
    s_branch L_after
L_save:
    v_mov_b32 v184, v136
    v_mov_b32 v185, v137
    v_mov_b32 v186, v140
    v_mov_b32 v187, v141
    v_mov_b32 v188, v144
    v_mov_b32 v189, v145
    v_mov_b32 v190, v148
    v_mov_b32 v191, v149
    v_mov_b32 v192, v152
    v_mov_b32 v193, v153
    v_mov_b32 v194, v156
    v_mov_b32 v195, v157
    v_mov_b32 v196, v160
    v_mov_b32 v197, v161
    v_mov_b32 v198, v164
    v_mov_b32 v199, v165
    v_mov_b32 v200, v17
    v_mov_b32 v201, v18
    s_mov_b32 s92, 1
    s_mov_b32 s66, 0
L_fresh:
    v_mov_b32 v136, 0
    v_mov_b32 v137, 0
    v_mov_b32 v140, 0
    v_mov_b32 v141, 0
    v_mov_b32 v144, 0
    v_mov_b32 v145, 0
    v_mov_b32 v148, 0
    v_mov_b32 v149, 0
    v_mov_b32 v152, 0
    v_mov_b32 v153, 0
    v_mov_b32 v156, 0
    v_mov_b32 v157, 0
    v_mov_b32 v160, 0
    v_mov_b32 v161, 0
    v_mov_b32 v164, 0
    v_mov_b32 v165, 0
    v_mov_b32 v17, 0xf149f2ca
    v_mov_b32 v18, 0
L_after:
    s_cmp_eq_u32 s65, 2
    s_cbranch_scc1 L_own_done
L_newseg:
    v_readlane_b32 s61, v10, s63
    v_readlane_b32 s55, v9, s63
    s_mov_b32 s70, 1
L_loop:
    s_mov_b32 s57, s62
    s_mov_b32 s58, s63
    s_mov_b32 s59, s64
    s_mov_b32 s60, s65
    s_mov_b32 s10, s93
    s_add_u32 s66, s66, 1
    s_cmp_eq_u32 s91, 0
    s_cbranch_scc1 L_w0
    s_cmp_ge_u32 s91, 9
    s_cbranch_scc1 L_w9
    s_cmp_ge_u32 s91, 3
    s_cbranch_scc1 L_w3
    s_waitcnt vmcnt(1)
    s_branch L_wdone
L_w9:
    s_waitcnt vmcnt(9)
    s_branch L_wdone
L_w3:
    s_waitcnt vmcnt(3)
    s_branch L_wdone
L_w0:
    s_waitcnt vmcnt(0)
L_wdone:
    s_mov_b32 s91, 0
    buffer_load_dwordx4 v[104:107], v1, s[8:11], s57 offen nt
    s_add_u32 s77, s57, 4096
    buffer_load_dwordx4 v[108:111], v1, s[8:11], s77 offen nt
    s_add_u32 s77, s57, 8192
    buffer_load_dwordx4 v[112:115], v1, s[8:11], s77 offen nt
    s_add_u32 s77, s57, 12288
    buffer_load_dwordx4 v[116:119], v1, s[8:11], s77 offen nt
    s_add_u32 s77, s57, 16384
    buffer_load_dwordx4 v[120:123], v1, s[8:11], s77 offen nt
    s_add_u32 s77, s57, 20480
    buffer_load_dwordx4 v[124:127], v1, s[8:11], s77 offen nt
    s_add_u32 s77, s57, 24576
    buffer_load_dwordx4 v[128:131], v1, s[8:11], s77 offen nt
    s_add_u32 s77, s57, 28672
    buffer_load_dwordx4 v[132:135], v1, s[8:11], s77 offen nt
    v_mov_b32 v20, 1
    s_mov_b64 exec, 1
    ds_add_rtn_u32 v30, v39, v20
    s_mov_b64 exec, -1
    s_cmp_eq_u32 s70, 0
    s_cbranch_scc1 L_noq
    ds_read_b128 v[40:43], v3 offset:0
    ds_read_b128 v[44:47], v3 offset:64
    ds_read_b128 v[48:51], v3 offset:128
    ds_read_b128 v[52:55], v3 offset:192
    ds_read_b128 v[56:59], v3 offset:256
    ds_read_b128 v[60:63], v3 offset:320
    ds_read_b128 v[64:67], v3 offset:384
    ds_read_b128 v[68:71], v3 offset:448
    s_mov_b32 s70, 0
L_noq:
    ds_read_b128 v[72:75], v2 offset:0
    ds_read_b128 v[76:79], v2 offset:64
    ds_read_b128 v[80:83], v2 offset:128
    ds_read_b128 v[84:87], v2 offset:192
    ds_read_b128 v[88:91], v2 offset:256
    ds_read_b128 v[92:95], v2 offset:320
    ds_read_b128 v[96:99], v2 offset:384
    ds_read_b128 v[100:103], v2 offset:448
    s_waitcnt lgkmcnt(7)
    v_mfma_f32_16x16x32_bf16 v[24:27], v[72:75], v[40:43], 0
    s_waitcnt lgkmcnt(6)
    v_mfma_f32_16x16x32_bf16 v[24:27], v[76:79], v[44:47], v[24:27]
    s_waitcnt lgkmcnt(5)
    v_mfma_f32_16x16x32_bf16 v[24:27], v[80:83], v[48:51], v[24:27]
    s_waitcnt lgkmcnt(4)
    v_mfma_f32_16x16x32_bf16 v[24:27], v[84:87], v[52:55], v[24:27]
    s_waitcnt lgkmcnt(3)
    v_mfma_f32_16x16x32_bf16 v[24:27], v[88:91], v[56:59], v[24:27]
    s_waitcnt lgkmcnt(2)
    v_mfma_f32_16x16x32_bf16 v[24:27], v[92:95], v[60:63], v[24:27]
    s_waitcnt lgkmcnt(1)
    v_mfma_f32_16x16x32_bf16 v[24:27], v[96:99], v[64:67], v[24:27]
    s_waitcnt lgkmcnt(0)
    v_mfma_f32_16x16x32_bf16 v[24:27], v[100:103], v[68:71], v[24:27]
    v_readfirstlane_b32 s75, v30
    s_and_b32 s74, s75, 0xffff
    s_lshr_b32 s75, s75, 16
    s_or_b32 s71, s71, s75
    s_cmp_eq_u32 s74, s72
    s_cselect_b32 s73, 2, s73
    s_cmp_ge_u32 s74, s30
    s_cbranch_scc1 L_dn_own2
    s_add_u32 s74, s74, s28
    v_cmp_ge_u32 vcc, s74, v12
    s_bcnt1_i32_b64 s63, vcc
    v_readlane_b32 s76, v12, s63
    v_readlane_b32 s75, v8, s63
    s_sub_u32 s76, s76, s74
    s_sub_u32 s64, s75, s76
    s_mov_b32 s65, 1
    s_branch L_dn_bt2
L_dn_own2:
    s_sub_u32 s74, s74, s30
    s_add_u32 s64, s74, 8
    s_mov_b32 s63, s56
    s_cmp_lt_u32 s64, s31
    s_cselect_b32 s65, 0, 2
    s_cselect_b32 s64, s64, 0
L_dn_bt2:
    s_and_b32 s74, s63, 31
    s_lshl_b32 s74, s74, 7
    s_add_u32 s74, s74, s64
    s_lshl_b32 s74, s74, 2
    v_mov_b32 v20, s74
    v_readlane_b32 s93, v9, s63
    s_lshr_b32 s85, s63, 5
    s_and_b32 s75, s54, 6
    s_or_b32 s85, s85, s75
    s_lshl_b32 s85, s85, 9
    s_lshl_b32 s75, s64, 4
    s_sub_u32 s93, s93, s75
    ds_read_b32 v38, v20
    s_lshl_b32 s74, s59, 4
    s_sub_u32 s74, s55, s74
    s_cmp_ge_u32 s74, 16
    s_cbranch_scc1 L_nomask
    v_cmp_gt_i32 vcc, s74, v5
    s_sub_u32 s74, s74, 1
    s_nop 0
    v_cndmask_b32 v24, v19, v24, vcc
    v_cmp_gt_i32 vcc, s74, v5
    s_sub_u32 s74, s74, 1
    s_nop 0
    v_cndmask_b32 v25, v19, v25, vcc
    v_cmp_gt_i32 vcc, s74, v5
    s_sub_u32 s74, s74, 1
    s_nop 0
    v_cndmask_b32 v26, v19, v26, vcc
    v_cmp_gt_i32 vcc, s74, v5
    s_sub_u32 s74, s74, 1
    s_nop 0
    v_cndmask_b32 v27, v19, v27, vcc
L_nomask:
    v_max3_f32 v20, v24, v25, v26
    v_max_f32 v20, v20, v27
    v_mov_b32 v21, v20
    s_nop 1
    v_permlane16_swap_b32 v20, v21
    v_max3_f32 v31, v20, v21, v17
    v_cmp_gt_f32 vcc, v31, v17
    s_cbranch_vccz L_norescale
    v_sub_f32 v22, v17, v31
    v_mul_f32 v22, s61, v22
    v_exp_f32 v22, v22
    v_mov_b32 v17, v31
    s_nop 0
    v_mul_f32 v18, v18, v22
    v_mul_f32_dpp v136, v22, v136 quad_perm:[0,0,2,2] row_mask:0xf bank_mask:0xf
    v_mul_f32_dpp v137, v22, v137 quad_perm:[1,1,3,3] row_mask:0xf bank_mask:0xf
    v_mul_f32_dpp v140, v22, v140 quad_perm:[0,0,2,2] row_mask:0xf bank_mask:0xf
    v_mul_f32_dpp v141, v22, v141 quad_perm:[1,1,3,3] row_mask:0xf bank_mask:0xf
    v_mul_f32_dpp v144, v22, v144 quad_perm:[0,0,2,2] row_mask:0xf bank_mask:0xf
    v_mul_f32_dpp v145, v22, v145 quad_perm:[1,1,3,3] row_mask:0xf bank_mask:0xf
    v_mul_f32_dpp v148, v22, v148 quad_perm:[0,0,2,2] row_mask:0xf bank_mask:0xf
    v_mul_f32_dpp v149, v22, v149 quad_perm:[1,1,3,3] row_mask:0xf bank_mask:0xf
    v_mul_f32_dpp v152, v22, v152 quad_perm:[0,0,2,2] row_mask:0xf bank_mask:0xf
    v_mul_f32_dpp v153, v22, v153 quad_perm:[1,1,3,3] row_mask:0xf bank_mask:0xf
    v_mul_f32_dpp v156, v22, v156 quad_perm:[0,0,2,2] row_mask:0xf bank_mask:0xf
    v_mul_f32_dpp v157, v22, v157 quad_perm:[1,1,3,3] row_mask:0xf bank_mask:0xf
    v_mul_f32_dpp v160, v22, v160 quad_perm:[0,0,2,2] row_mask:0xf bank_mask:0xf
    v_mul_f32_dpp v161, v22, v161 quad_perm:[1,1,3,3] row_mask:0xf bank_mask:0xf
    v_mul_f32_dpp v164, v22, v164 quad_perm:[0,0,2,2] row_mask:0xf bank_mask:0xf
    v_mul_f32_dpp v165, v22, v165 quad_perm:[1,1,3,3] row_mask:0xf bank_mask:0xf
L_norescale:
    v_mul_f32 v20, s61, v17
    v_fma_f32 v24, v24, s61, -v20
    v_fma_f32 v25, v25, s61, -v20
    v_fma_f32 v26, v26, s61, -v20
    v_fma_f32 v27, v27, s61, -v20
    v_exp_f32 v24, v24
    v_exp_f32 v25, v25
    v_exp_f32 v26, v26
    v_exp_f32 v27, v27
    s_waitcnt lgkmcnt(0)
    v_readfirstlane_b32 s62, v38
    s_lshl_b32 s62, s62, 16
    s_lshl_b32 s74, s93, 12
    s_add_u32 s74, s74, s62
    s_cmp_lt_u32 s93, 16
    s_cselect_b32 s93, s74, 268697600
    s_add_u32 s62, s62, s85
    s_cmp_eq_u32 s65, 2
    s_cselect_b32 s62, 536870912, s62
    v_add_f32 v20, v24, v25
    v_add_f32 v21, v26, v27
    v_cvt_pk_bf16_f32 v28, v24, v25
    v_cvt_pk_bf16_f32 v29, v26, v27
    v_add_f32 v20, v20, v21
    v_add_f32 v18, v18, v20
    s_cmp_lg_u32 s63, s58
    s_cselect_b32 s89, 1, 0
    s_cmp_lg_u32 s65, s60
    s_cselect_b32 s89, 1, s89
    s_waitcnt vmcnt(0)
    s_cmp_eq_u32 s89, 0
    s_cbranch_scc1 L_sameseg
    s_lshl_b32 s75, s85, 1
    s_and_b32 s76, s63, 31
    s_lshl_b32 s76, s76, 13
    s_mov_b32 m0, s84
    s_add_u32 s75, s75, s76
    buffer_load_dwordx4 v4, s[12:15], s75 offen lds
L_sameseg:
    s_mov_b32 m0, s83
    s_mov_b32 s6, s93
    s_mov_b32 s77, s62
    buffer_load_dwordx4 v1, s[4:7], s77 offen nt lds
    s_add_u32 m0, m0, 1056
    s_add_u32 s77, s77, 4096
    buffer_load_dwordx4 v1, s[4:7], s77 offen nt lds
    s_add_u32 m0, m0, 1056
    s_add_u32 s77, s77, 4096
    buffer_load_dwordx4 v1, s[4:7], s77 offen nt lds
    s_add_u32 m0, m0, 1056
    s_add_u32 s77, s77, 4096
    buffer_load_dwordx4 v1, s[4:7], s77 offen nt lds
    s_add_u32 m0, m0, 1056
    s_add_u32 s77, s77, 4096
    buffer_load_dwordx4 v1, s[4:7], s77 offen nt lds
    s_add_u32 m0, m0, 1056
    s_add_u32 s77, s77, 4096
    buffer_load_dwordx4 v1, s[4:7], s77 offen nt lds
    s_add_u32 m0, m0, 1056
    s_add_u32 s77, s77, 4096
    buffer_load_dwordx4 v1, s[4:7], s77 offen nt lds
    s_add_u32 m0, m0, 1056
    s_add_u32 s77, s77, 4096
    buffer_load_dwordx4 v1, s[4:7], s77 offen nt lds
    s_cmp_eq_u32 s68, 0
    s_cbranch_scc1 L_nopenda
    s_and_b32 s74, s67, 31
    s_lshl_b32 s74, s74, 3
    s_and_b32 s75, s54, 4
    s_add_u32 s74, s74, s75
    s_lshr_b32 s75, s67, 5
    s_and_b32 s77, s54, 2
    s_or_b32 s75, s75, s77
    s_lshl_b32 s75, s75, 3
    s_lshl_b32 s75, s68, s75
    s_lshl_b32 s76, s68, 8
    s_or_b32 s76, s76, s67
    v_mov_b32 v22, s74
    s_lshl_b64 exec, 1, s69
    v_mov_b32 v16, s76
    v_mov_b32 v36, s75
    buffer_atomic_add v36, v22, s[20:23], 0 offen sc0
    s_mov_b64 exec, -1
    s_add_u32 s69, s69, 1
    s_mov_b32 s68, 0
    s_add_u32 s91, s91, 1
L_nopenda:
    s_cmp_lg_u32 s73, 1
    s_cbranch_scc1 L_nochka
    v_readfirstlane_b32 s74, v37
    s_and_b32 s75, s54, 3
    s_lshl_b32 s75, s75, 3
    s_lshr_b32 s74, s74, s75
    s_and_b32 s74, s74, 0xff
    s_cmp_lg_u32 s74, s32
    s_cbranch_scc1 L_chknoa
    v_mov_b32 v22, 0x10000
    ds_or_b32 v39, v22
L_chknoa:
    s_mov_b32 s73, 0
L_nochka:
    s_cmp_lg_u32 s73, 2
    s_cbranch_scc1 L_nochk2
    s_and_b32 s74, s56, 31
    s_lshl_b32 s74, s74, 3
    s_and_b32 s75, s54, 4
    s_add_u32 s74, s74, s75
    s_lshr_b32 s75, s56, 5
    s_and_b32 s77, s54, 2
    s_or_b32 s75, s75, s77
    s_lshl_b32 s75, s75, 3
    v_mov_b32 v22, s74
    buffer_load_dword v37, v22, s[20:23], 0 offen sc1
    s_mov_b32 s73, 1
    s_add_u32 s91, s91, 1
L_nochk2:
    s_cmp_lg_u32 s71, 1
    s_cbranch_scc1 L_nopf
    s_mov_b32 s90, s33
    s_mov_b32 s75, s82
    s_lshl_b32 s74, s90, 2
    s_lshr_b32 s76, s54, 1
    s_add_u32 s74, s74, s76
    s_lshl_b32 s76, s74, 11
    s_lshl_b32 s74, s74, 7
    s_add_u32 s74, s74, 8388608
    s_and_b32 s77, s52, 4
    s_lshl_b32 s77, s77, 1
    s_add_u32 s74, s74, s77
    s_min_u32 s75, s75, 8
    v_and_b32 v20, 15, v0
    v_cmp_gt_u32 vcc, s75, v20
    v_lshlrev_b32 v20, 9, v20
    v_mov_b32 v21, 1610612736
    s_nop 0
    v_cndmask_b32 v21, v21, v20, vcc
    buffer_load_dwordx2 v[176:177], v21, s[16:19], s74 offen sc1
    s_cmp_gt_u32 s75, 0
    s_cselect_b32 s77, s76, 1610612736
    buffer_load_dword v168, v178, s[16:19], s77 offen sc1
    s_add_u32 s76, s76, 8192
    s_cmp_gt_u32 s75, 1
    s_cselect_b32 s77, s76, 1610612736
    buffer_load_dword v169, v178, s[16:19], s77 offen sc1
    s_add_u32 s76, s76, 8192
    s_cmp_gt_u32 s75, 2
    s_cselect_b32 s77, s76, 1610612736
    buffer_load_dword v170, v178, s[16:19], s77 offen sc1
    s_add_u32 s76, s76, 8192
    s_cmp_gt_u32 s75, 3
    s_cselect_b32 s77, s76, 1610612736
    buffer_load_dword v171, v178, s[16:19], s77 offen sc1
    s_add_u32 s76, s76, 8192
    s_cmp_gt_u32 s75, 4
    s_cselect_b32 s77, s76, 1610612736
    buffer_load_dword v172, v178, s[16:19], s77 offen sc1
    s_add_u32 s76, s76, 8192
    s_cmp_gt_u32 s75, 5
    s_cselect_b32 s77, s76, 1610612736
    buffer_load_dword v173, v178, s[16:19], s77 offen sc1
    s_add_u32 s76, s76, 8192
    s_cmp_gt_u32 s75, 6
    s_cselect_b32 s77, s76, 1610612736
    buffer_load_dword v174, v178, s[16:19], s77 offen sc1
    s_add_u32 s76, s76, 8192
    s_cmp_gt_u32 s75, 7
    s_cselect_b32 s77, s76, 1610612736
    buffer_load_dword v175, v178, s[16:19], s77 offen sc1
    s_add_u32 s76, s76, 8192
    s_mov_b32 s71, 3
    s_add_u32 s91, s91, 9
L_nopf:
    v_perm_b32 v72, v108, v104, s86
    v_perm_b32 v73, v116, v112, s86
    v_perm_b32 v74, v108, v104, s87
    v_perm_b32 v75, v116, v112, s87
    v_perm_b32 v76, v109, v105, s86
    v_perm_b32 v77, v117, v113, s86
    v_perm_b32 v78, v109, v105, s87
    v_perm_b32 v79, v117, v113, s87
    v_perm_b32 v80, v110, v106, s86
    v_perm_b32 v81, v118, v114, s86
    v_perm_b32 v82, v110, v106, s87
    v_perm_b32 v83, v118, v114, s87
    v_perm_b32 v84, v111, v107, s86
    v_perm_b32 v85, v119, v115, s86
    v_perm_b32 v86, v111, v107, s87
    v_perm_b32 v87, v119, v115, s87
    v_mfma_f32_4x4x4_16b_bf16 v[136:139], v[28:29], v[72:73], v[136:139] cbsz:3 abid:0
    v_perm_b32 v88, v124, v120, s86
    v_perm_b32 v89, v132, v128, s86
    v_mfma_f32_4x4x4_16b_bf16 v[140:143], v[28:29], v[74:75], v[140:143] cbsz:3 abid:0
    v_perm_b32 v90, v124, v120, s87
    v_perm_b32 v91, v132, v128, s87
    v_mfma_f32_4x4x4_16b_bf16 v[144:147], v[28:29], v[76:77], v[144:147] cbsz:3 abid:0
    v_perm_b32 v92, v125, v121, s86
    v_perm_b32 v93, v133, v129, s86
    v_mfma_f32_4x4x4_16b_bf16 v[148:151], v[28:29], v[78:79], v[148:151] cbsz:3 abid:0
    v_perm_b32 v94, v125, v121, s87
    v_perm_b32 v95, v133, v129, s87
    v_mfma_f32_4x4x4_16b_bf16 v[152:155], v[28:29], v[80:81], v[152:155] cbsz:3 abid:0
    v_perm_b32 v96, v126, v122, s86
    v_perm_b32 v97, v134, v130, s86
    v_mfma_f32_4x4x4_16b_bf16 v[156:159], v[28:29], v[82:83], v[156:159] cbsz:3 abid:0
    v_perm_b32 v98, v126, v122, s87
    v_perm_b32 v99, v134, v130, s87
    v_mfma_f32_4x4x4_16b_bf16 v[160:163], v[28:29], v[84:85], v[160:163] cbsz:3 abid:0
    v_perm_b32 v100, v127, v123, s86
    v_perm_b32 v101, v135, v131, s86
    v_mfma_f32_4x4x4_16b_bf16 v[164:167], v[28:29], v[86:87], v[164:167] cbsz:3 abid:0
    v_perm_b32 v102, v127, v123, s87
    v_perm_b32 v103, v135, v131, s87
    s_nop 0
    v_mfma_f32_4x4x4_16b_bf16 v[136:139], v[28:29], v[88:89], v[136:139] cbsz:3 abid:4
    v_mfma_f32_4x4x4_16b_bf16 v[140:143], v[28:29], v[90:91], v[140:143] cbsz:3 abid:4
    v_mfma_f32_4x4x4_16b_bf16 v[144:147], v[28:29], v[92:93], v[144:147] cbsz:3 abid:4
    v_mfma_f32_4x4x4_16b_bf16 v[148:151], v[28:29], v[94:95], v[148:151] cbsz:3 abid:4
    v_mfma_f32_4x4x4_16b_bf16 v[152:155], v[28:29], v[96:97], v[152:155] cbsz:3 abid:4
    v_mfma_f32_4x4x4_16b_bf16 v[156:159], v[28:29], v[98:99], v[156:159] cbsz:3 abid:4
    v_mfma_f32_4x4x4_16b_bf16 v[160:163], v[28:29], v[100:101], v[160:163] cbsz:3 abid:4
    v_mfma_f32_4x4x4_16b_bf16 v[164:167], v[28:29], v[102:103], v[164:167] cbsz:3 abid:4
    s_cmp_eq_u32 s89, 0
    s_cbranch_scc1 L_loop
    s_cmp_lg_u32 s60, 0
    s_cbranch_scc1 L_deposit
    s_cmp_eq_u32 s65, 1
    s_nop 0
    s_cbranch_scc1 L_save
L_own_done:
    v_readlane_b32 s61, v10, s53
    s_nop 1
    v_mov_b32 v20, v18
    v_mov_b32 v21, v17
    v_mov_b32 v22, v17
    s_nop 0
    v_permlane16_swap_b32 v18, v20
    v_permlane32_swap_b32 v21, v22
    v_add_f32 v18, v18, v20
    v_max_f32 v31, v21, v22
    v_sub_f32 v22, v17, v31
    v_mul_f32 v22, s61, v22
    v_exp_f32 v22, v22
    v_mul_f32 v34, s61, v31
    s_nop 0
    v_mul_f32 v18, v18, v22
    v_mul_f32_dpp v136, v22, v136 quad_perm:[0,0,2,2] row_mask:0xf bank_mask:0xf
    v_mul_f32_dpp v137, v22, v137 quad_perm:[1,1,3,3] row_mask:0xf bank_mask:0xf
    v_mul_f32_dpp v140, v22, v140 quad_perm:[0,0,2,2] row_mask:0xf bank_mask:0xf
    v_mul_f32_dpp v141, v22, v141 quad_perm:[1,1,3,3] row_mask:0xf bank_mask:0xf
    v_mul_f32_dpp v144, v22, v144 quad_perm:[0,0,2,2] row_mask:0xf bank_mask:0xf
    v_mul_f32_dpp v145, v22, v145 quad_perm:[1,1,3,3] row_mask:0xf bank_mask:0xf
    v_mul_f32_dpp v148, v22, v148 quad_perm:[0,0,2,2] row_mask:0xf bank_mask:0xf
    v_mul_f32_dpp v149, v22, v149 quad_perm:[1,1,3,3] row_mask:0xf bank_mask:0xf
    v_mul_f32_dpp v152, v22, v152 quad_perm:[0,0,2,2] row_mask:0xf bank_mask:0xf
    v_mul_f32_dpp v153, v22, v153 quad_perm:[1,1,3,3] row_mask:0xf bank_mask:0xf
    v_mul_f32_dpp v156, v22, v156 quad_perm:[0,0,2,2] row_mask:0xf bank_mask:0xf
    v_mul_f32_dpp v157, v22, v157 quad_perm:[1,1,3,3] row_mask:0xf bank_mask:0xf
    v_mul_f32_dpp v160, v22, v160 quad_perm:[0,0,2,2] row_mask:0xf bank_mask:0xf
    v_mul_f32_dpp v161, v22, v161 quad_perm:[1,1,3,3] row_mask:0xf bank_mask:0xf
    v_mul_f32_dpp v164, v22, v164 quad_perm:[0,0,2,2] row_mask:0xf bank_mask:0xf
    v_mul_f32_dpp v165, v22, v165 quad_perm:[1,1,3,3] row_mask:0xf bank_mask:0xf
    v_mov_b32 v20, v18
    s_nop 1
    v_permlane32_swap_b32 v18, v20
    v_permlane32_swap_b32 v136, v137
    v_permlane32_swap_b32 v140, v141
    v_permlane32_swap_b32 v144, v145
    v_permlane32_swap_b32 v148, v149
    v_permlane32_swap_b32 v152, v153
    v_permlane32_swap_b32 v156, v157
    v_permlane32_swap_b32 v160, v161
    v_permlane32_swap_b32 v164, v165
    v_add_f32 v35, v18, v20
    v_add_f32 v72, v136, v137
    v_add_f32 v73, v140, v141
    v_add_f32 v74, v144, v145
    v_add_f32 v75, v148, v149
    v_add_f32 v76, v152, v153
    v_add_f32 v77, v156, v157
    v_add_f32 v78, v160, v161
    v_add_f32 v79, v164, v165
    v_lshlrev_b32 v20, 3, v0
    s_waitcnt vmcnt(0)
    v_add_u32 v21, s83, v6
    v_add_u32 v20, s83, v20
    ds_write_b128 v21, v[72:75]
    ds_write_b128 v21, v[76:79] offset:512
    s_mov_b64 exec, 3
    ds_write_b64 v20, v[34:35] offset:2048
    s_mov_b64 exec, -1
    s_cmp_eq_u32 s68, 0
    s_cbranch_scc1 L_nopendb
    s_and_b32 s74, s67, 31
    s_lshl_b32 s74, s74, 3
    s_and_b32 s75, s54, 4
    s_add_u32 s74, s74, s75
    s_lshr_b32 s75, s67, 5
    s_and_b32 s77, s54, 2
    s_or_b32 s75, s75, s77
    s_lshl_b32 s75, s75, 3
    s_lshl_b32 s75, s68, s75
    s_lshl_b32 s76, s68, 8
    s_or_b32 s76, s76, s67
    v_mov_b32 v22, s74
    s_lshl_b64 exec, 1, s69
    v_mov_b32 v16, s76
    v_mov_b32 v36, s75
    buffer_atomic_add v36, v22, s[20:23], 0 offen sc0
    s_mov_b64 exec, -1
    s_add_u32 s69, s69, 1
    s_mov_b32 s68, 0
    s_add_u32 s91, s91, 1
L_nopendb:
    s_cmp_lg_u32 s73, 1
    s_cbranch_scc1 L_nochkb
    v_readfirstlane_b32 s74, v37
    s_and_b32 s75, s54, 3
    s_lshl_b32 s75, s75, 3
    s_lshr_b32 s74, s74, s75
    s_and_b32 s74, s74, 0xff
    s_cmp_lg_u32 s74, s32
    s_cbranch_scc1 L_chknob
    v_mov_b32 v22, 0x10000
    ds_or_b32 v39, v22
L_chknob:
    s_mov_b32 s73, 0
L_nochkb:
    v_and_b32 v20, 7, v0
    v_mul_u32_u24 v20, 8448, v20
    s_and_b32 s74, s52, 4
    s_lshl_b32 s74, s74, 1
    s_add_u32 s74, s74, 18432
    v_add_u32 v20, s74, v20
    v_add_u32 v21, 16384, v178
    s_waitcnt lgkmcnt(0)
    s_barrier
    ds_read_b32 v30, v39
    ds_read_b64 v[182:183], v20
    ds_read_b32 v72, v21 offset:0
    ds_read_b32 v73, v21 offset:8448
    ds_read_b32 v74, v21 offset:16896
    ds_read_b32 v75, v21 offset:25344
    ds_read_b32 v76, v21 offset:33792
    ds_read_b32 v77, v21 offset:42240
    ds_read_b32 v78, v21 offset:50688
    ds_read_b32 v79, v21 offset:59136
    s_cmp_eq_u32 s32, 0
    s_cbranch_scc1 L_fast
    s_waitcnt lgkmcnt(9)
    v_readfirstlane_b32 s74, v30
    s_lshr_b32 s74, s74, 16
    s_cmp_lg_u32 s74, 0
    s_cbranch_scc1 L_fast
    s_cmp_lg_u32 s52, 0
    s_cbranch_scc1 L_rechk
    s_and_b32 s74, s56, 31
    s_lshl_b32 s74, s74, 3
    s_and_b32 s75, s54, 4
    s_add_u32 s74, s74, s75
    s_lshr_b32 s75, s56, 5
    s_and_b32 s77, s54, 2
    s_or_b32 s75, s75, s77
    s_lshl_b32 s75, s75, 3
    v_mov_b32 v22, s74
    buffer_load_dword v37, v22, s[20:23], 0 offen sc1
    s_waitcnt vmcnt(0)
    v_readfirstlane_b32 s74, v37
    s_and_b32 s75, s54, 3
    s_lshl_b32 s75, s75, 3
    s_lshr_b32 s74, s74, s75
    s_and_b32 s74, s74, 0xff
    s_cmp_lg_u32 s74, s32
    s_cbranch_scc1 L_chknoc
    v_mov_b32 v22, 0x10000
    ds_or_b32 v39, v22 offset:4
L_chknoc:
    s_waitcnt lgkmcnt(0)
L_rechk:
    s_barrier
    ds_read_b32 v30, v39 offset:4
    s_waitcnt lgkmcnt(0)
    v_readfirstlane_b32 s74, v30
    s_lshr_b32 s74, s74, 16
    s_cmp_lg_u32 s74, 0
    s_cbranch_scc1 L_fast
    s_mov_b32 s82, 0
    s_mov_b32 s71, 4
L_fast:
    s_mov_b32 s90, s33
    s_mov_b32 s88, 0
    s_and_b32 s74, s71, 6
    s_cmp_lg_u32 s74, 0
    s_cbranch_scc1 L_havepf
    s_mov_b32 s75, s82
    s_lshl_b32 s74, s90, 2
    s_lshr_b32 s76, s54, 1
    s_add_u32 s74, s74, s76
    s_lshl_b32 s76, s74, 11
    s_lshl_b32 s74, s74, 7
    s_add_u32 s74, s74, 8388608
    s_and_b32 s77, s52, 4
    s_lshl_b32 s77, s77, 1
    s_add_u32 s74, s74, s77
    s_min_u32 s75, s75, 8
    v_and_b32 v20, 15, v0
    v_cmp_gt_u32 vcc, s75, v20
    v_lshlrev_b32 v20, 9, v20
    v_mov_b32 v21, 1610612736
    s_nop 0
    v_cndmask_b32 v21, v21, v20, vcc
    buffer_load_dwordx2 v[176:177], v21, s[16:19], s74 offen sc1
    s_cmp_gt_u32 s75, 0
    s_cselect_b32 s77, s76, 1610612736
    buffer_load_dword v168, v178, s[16:19], s77 offen sc1
    s_add_u32 s76, s76, 8192
    s_cmp_gt_u32 s75, 1
    s_cselect_b32 s77, s76, 1610612736
    buffer_load_dword v169, v178, s[16:19], s77 offen sc1
    s_add_u32 s76, s76, 8192
    s_cmp_gt_u32 s75, 2
    s_cselect_b32 s77, s76, 1610612736
    buffer_load_dword v170, v178, s[16:19], s77 offen sc1
    s_add_u32 s76, s76, 8192
    s_cmp_gt_u32 s75, 3
    s_cselect_b32 s77, s76, 1610612736
    buffer_load_dword v171, v178, s[16:19], s77 offen sc1
    s_add_u32 s76, s76, 8192
    s_cmp_gt_u32 s75, 4
    s_cselect_b32 s77, s76, 1610612736
    buffer_load_dword v172, v178, s[16:19], s77 offen sc1
    s_add_u32 s76, s76, 8192
    s_cmp_gt_u32 s75, 5
    s_cselect_b32 s77, s76, 1610612736
    buffer_load_dword v173, v178, s[16:19], s77 offen sc1
    s_add_u32 s76, s76, 8192
    s_cmp_gt_u32 s75, 6
    s_cselect_b32 s77, s76, 1610612736
    buffer_load_dword v174, v178, s[16:19], s77 offen sc1
    s_add_u32 s76, s76, 8192
    s_cmp_gt_u32 s75, 7
    s_cselect_b32 s77, s76, 1610612736
    buffer_load_dword v175, v178, s[16:19], s77 offen sc1
    s_add_u32 s76, s76, 8192
L_havepf:
    s_min_u32 s75, s82, 8
    v_and_b32 v20, 15, v0
    v_cmp_gt_u32 vcc, s75, v20
    v_cmp_gt_u32 s[76:77], 8, v20
    s_waitcnt vmcnt(0) lgkmcnt(0)
    v_cndmask_b32 v176, v19, v176, vcc
    v_cndmask_b32 v177, 0, v177, vcc
    v_cndmask_b32 v182, v19, v182, s[76:77]
    v_max_f32 v17, v176, v182
    s_nop 1
    v_max_f32_dpp v17, v17, v17 row_ror:1 row_mask:0xf bank_mask:0xf
    s_nop 1
    v_max_f32_dpp v17, v17, v17 row_ror:2 row_mask:0xf bank_mask:0xf
    s_nop 1
    v_max_f32_dpp v17, v17, v17 row_ror:4 row_mask:0xf bank_mask:0xf
    s_nop 1
    v_max_f32_dpp v17, v17, v17 row_ror:8 row_mask:0xf bank_mask:0xf
    v_sub_f32 v179, v182, v17
    v_sub_f32 v180, v176, v17
    v_exp_f32 v179, v179
    v_exp_f32 v180, v180
    v_mov_b32 v23, 0
    v_mul_f32 v18, v179, v183
    v_fmac_f32 v18, v180, v177
    v_fmac_f32_dpp v23, v179, v72 row_newbcast:0 row_mask:0xf bank_mask:0xf
    v_fmac_f32_dpp v23, v179, v73 row_newbcast:1 row_mask:0xf bank_mask:0xf
    v_fmac_f32_dpp v23, v179, v74 row_newbcast:2 row_mask:0xf bank_mask:0xf
    v_fmac_f32_dpp v23, v179, v75 row_newbcast:3 row_mask:0xf bank_mask:0xf
    v_fmac_f32_dpp v23, v179, v76 row_newbcast:4 row_mask:0xf bank_mask:0xf
    v_fmac_f32_dpp v23, v179, v77 row_newbcast:5 row_mask:0xf bank_mask:0xf
    v_fmac_f32_dpp v23, v179, v78 row_newbcast:6 row_mask:0xf bank_mask:0xf
    v_fmac_f32_dpp v23, v179, v79 row_newbcast:7 row_mask:0xf bank_mask:0xf
    v_add_f32_dpp v18, v18, v18 row_ror:1 row_mask:0xf bank_mask:0xf
    s_nop 1
    v_add_f32_dpp v18, v18, v18 row_ror:2 row_mask:0xf bank_mask:0xf
    s_nop 1
    v_add_f32_dpp v18, v18, v18 row_ror:4 row_mask:0xf bank_mask:0xf
    s_nop 1
    v_add_f32_dpp v18, v18, v18 row_ror:8 row_mask:0xf bank_mask:0xf
    s_nop 1
    s_cmp_eq_u32 s82, 0
    s_cbranch_scc1 L_merged
    v_fmac_f32_dpp v23, v180, v168 row_newbcast:0 row_mask:0xf bank_mask:0xf
    v_fmac_f32_dpp v23, v180, v169 row_newbcast:1 row_mask:0xf bank_mask:0xf
    v_fmac_f32_dpp v23, v180, v170 row_newbcast:2 row_mask:0xf bank_mask:0xf
    v_fmac_f32_dpp v23, v180, v171 row_newbcast:3 row_mask:0xf bank_mask:0xf
    v_fmac_f32_dpp v23, v180, v172 row_newbcast:4 row_mask:0xf bank_mask:0xf
    v_fmac_f32_dpp v23, v180, v173 row_newbcast:5 row_mask:0xf bank_mask:0xf
    v_fmac_f32_dpp v23, v180, v174 row_newbcast:6 row_mask:0xf bank_mask:0xf
    v_fmac_f32_dpp v23, v180, v175 row_newbcast:7 row_mask:0xf bank_mask:0xf
L_more:
    s_add_u32 s88, s88, 8
    s_cmp_ge_u32 s88, s82
    s_cbranch_scc1 L_merged
    s_add_u32 s90, s90, 8
    s_sub_u32 s75, s82, s88
    s_lshl_b32 s74, s90, 2
    s_lshr_b32 s76, s54, 1
    s_add_u32 s74, s74, s76
    s_lshl_b32 s76, s74, 11
    s_lshl_b32 s74, s74, 7
    s_add_u32 s74, s74, 8388608
    s_and_b32 s77, s52, 4
    s_lshl_b32 s77, s77, 1
    s_add_u32 s74, s74, s77
    s_min_u32 s75, s75, 8
    v_and_b32 v20, 15, v0
    v_cmp_gt_u32 vcc, s75, v20
    v_lshlrev_b32 v20, 9, v20
    v_mov_b32 v21, 1610612736
    s_nop 0
    v_cndmask_b32 v21, v21, v20, vcc
    buffer_load_dwordx2 v[176:177], v21, s[16:19], s74 offen sc1
    s_cmp_gt_u32 s75, 0
    s_cselect_b32 s77, s76, 1610612736
    buffer_load_dword v168, v178, s[16:19], s77 offen sc1
    s_add_u32 s76, s76, 8192
    s_cmp_gt_u32 s75, 1
    s_cselect_b32 s77, s76, 1610612736
    buffer_load_dword v169, v178, s[16:19], s77 offen sc1
    s_add_u32 s76, s76, 8192
    s_cmp_gt_u32 s75, 2
    s_cselect_b32 s77, s76, 1610612736
    buffer_load_dword v170, v178, s[16:19], s77 offen sc1
    s_add_u32 s76, s76, 8192
    s_cmp_gt_u32 s75, 3
    s_cselect_b32 s77, s76, 1610612736
    buffer_load_dword v171, v178, s[16:19], s77 offen sc1
    s_add_u32 s76, s76, 8192
    s_cmp_gt_u32 s75, 4
    s_cselect_b32 s77, s76, 1610612736
    buffer_load_dword v172, v178, s[16:19], s77 offen sc1
    s_add_u32 s76, s76, 8192
    s_cmp_gt_u32 s75, 5
    s_cselect_b32 s77, s76, 1610612736
    buffer_load_dword v173, v178, s[16:19], s77 offen sc1
    s_add_u32 s76, s76, 8192
    s_cmp_gt_u32 s75, 6
    s_cselect_b32 s77, s76, 1610612736
    buffer_load_dword v174, v178, s[16:19], s77 offen sc1
    s_add_u32 s76, s76, 8192
    s_cmp_gt_u32 s75, 7
    s_cselect_b32 s77, s76, 1610612736
    buffer_load_dword v175, v178, s[16:19], s77 offen sc1
    s_add_u32 s76, s76, 8192
    s_waitcnt vmcnt(0)
    v_cndmask_b32 v176, v19, v176, vcc
    v_max_f32 v20, v176, v17
    s_nop 1
    v_max_f32_dpp v20, v20, v20 row_ror:1 row_mask:0xf bank_mask:0xf
    s_nop 1
    v_max_f32_dpp v20, v20, v20 row_ror:2 row_mask:0xf bank_mask:0xf
    s_nop 1
    v_max_f32_dpp v20, v20, v20 row_ror:4 row_mask:0xf bank_mask:0xf
    s_nop 1
    v_max_f32_dpp v20, v20, v20 row_ror:8 row_mask:0xf bank_mask:0xf
    v_sub_f32 v180, v176, v20
    v_sub_f32 v21, v17, v20
    v_exp_f32 v180, v180
    v_exp_f32 v21, v21
    v_mov_b32 v17, v20
    v_mul_f32 v22, v180, v177
    s_nop 1
    v_add_f32_dpp v22, v22, v22 row_ror:1 row_mask:0xf bank_mask:0xf
    s_nop 1
    v_add_f32_dpp v22, v22, v22 row_ror:2 row_mask:0xf bank_mask:0xf
    s_nop 1
    v_add_f32_dpp v22, v22, v22 row_ror:4 row_mask:0xf bank_mask:0xf
    s_nop 1
    v_add_f32_dpp v22, v22, v22 row_ror:8 row_mask:0xf bank_mask:0xf
    v_fma_f32 v18, v18, v21, v22
    v_mul_f32 v23, v23, v21
    v_fmac_f32_dpp v23, v180, v168 row_newbcast:0 row_mask:0xf bank_mask:0xf
    v_fmac_f32_dpp v23, v180, v169 row_newbcast:1 row_mask:0xf bank_mask:0xf
    v_fmac_f32_dpp v23, v180, v170 row_newbcast:2 row_mask:0xf bank_mask:0xf
    v_fmac_f32_dpp v23, v180, v171 row_newbcast:3 row_mask:0xf bank_mask:0xf
    v_fmac_f32_dpp v23, v180, v172 row_newbcast:4 row_mask:0xf bank_mask:0xf
    v_fmac_f32_dpp v23, v180, v173 row_newbcast:5 row_mask:0xf bank_mask:0xf
    v_fmac_f32_dpp v23, v180, v174 row_newbcast:6 row_mask:0xf bank_mask:0xf
    v_fmac_f32_dpp v23, v180, v175 row_newbcast:7 row_mask:0xf bank_mask:0xf
    s_branch L_more
L_merged:
    s_cmp_eq_u32 s71, 4
    s_cbranch_scc1 L_slow
    v_rcp_f32 v20, v18
    s_lshl_b32 s74, s53, 3
    s_add_u32 s74, s74, s54
    s_lshl_b32 s74, s74, 10
    v_bfe_u32 v21, v178, 4, 5
    v_lshlrev_b32 v21, 4, v21
    v_bfe_u32 v22, v178, 2, 2
    v_lshl_add_u32 v21, v22, 1, v21
    s_bfe_u32 s75, s52, 0x10001
    s_lshl_b32 s75, s75, 3
    s_add_u32 s74, s74, s75
    s_and_b32 s75, s52, 4
    s_lshl_b32 s75, s75, 7
    s_add_u32 s74, s74, s75
    v_mul_f32 v23, v23, v20
    v_cvt_pk_bf16_f32 v23, v23, v23
    buffer_store_short v23, v21, s[24:27], s74 offen
    s_branch L_tail
L_slow:
    s_add_u32 s90, s56, 128
    s_lshl_b32 s74, s90, 2
    s_lshr_b32 s75, s54, 1
    s_add_u32 s74, s74, s75
    s_lshl_b32 s75, s74, 11
    s_lshl_b32 s74, s74, 7
    s_add_u32 s74, s74, 8388608
    s_and_b32 s76, s52, 4
    s_lshl_b32 s76, s76, 1
    s_add_u32 s74, s74, s76
    v_mov_b32 v34, v17
    v_mov_b32 v35, v18
    v_mov_b32 v20, 0
    buffer_store_dword v23, v178, s[16:19], s75 offen sc1
    s_mov_b64 exec, 1
    buffer_store_dwordx2 v[34:35], v20, s[16:19], s74 offen sc1
    s_mov_b64 exec, -1
    s_waitcnt vmcnt(0)
    s_barrier
    s_cmp_lg_u32 s52, 0
    s_cbranch_scc1 L_tail
    s_mov_b32 s89, 128
    s_and_b32 s74, s56, 31
    s_lshl_b32 s74, s74, 3
    s_and_b32 s75, s54, 4
    s_add_u32 s74, s74, s75
    s_lshr_b32 s75, s56, 5
    s_and_b32 s77, s54, 2
    s_or_b32 s75, s75, s77
    s_lshl_b32 s75, s75, 3
    s_lshl_b32 s75, s89, s75
    s_lshl_b32 s76, s89, 8
    s_or_b32 s76, s76, s56
    v_mov_b32 v22, s74
    s_lshl_b64 exec, 1, s69
    v_mov_b32 v16, s76
    v_mov_b32 v36, s75
    buffer_atomic_add v36, v22, s[20:23], 0 offen sc0
    s_mov_b64 exec, -1
    s_add_u32 s69, s69, 1
L_tail:
    s_cmp_eq_u32 s69, 0
    s_cbranch_scc1 L_fin
    s_mov_b32 s89, 0
    s_waitcnt vmcnt(0)
L_chk:
    s_cmp_ge_u32 s89, s69
    s_cbranch_scc1 L_fin
    v_readlane_b32 s77, v16, s89
    v_readlane_b32 s74, v36, s89
    s_add_u32 s89, s89, 1
    s_and_b32 s58, s77, 63
    v_readlane_b32 s76, v11, s58
    s_lshr_b32 s60, s58, 5
    s_and_b32 s75, s54, 6
    s_or_b32 s60, s60, s75
    s_and_b32 s75, s60, 3
    s_lshl_b32 s75, s75, 3
    s_lshr_b32 s74, s74, s75
    s_and_b32 s74, s74, 0xff
    s_bfe_u32 s77, s77, 0x80008
    s_add_u32 s74, s74, s77
    s_add_u32 s76, s76, 128
    s_cmp_lg_u32 s74, s76
    s_cbranch_scc1 L_chk
    v_readlane_b32 s74, v12, s58
    v_readlane_b32 s88, v11, s58
    s_sub_u32 s88, s74, s88
    s_sub_u32 s74, s74, 1
    v_cmp_ge_u32 vcc, s74, v14
    s_and_b64 s[76:77], vcc, s[80:81]
    s_bcnt1_i32_b64 s82, s[76:77]
    v_cmp_ge_u32 vcc, s88, v14
    s_and_b64 s[76:77], vcc, s[80:81]
    s_bcnt1_i32_b64 s33, s[76:77]
    s_sub_u32 s82, s82, s33
    s_add_u32 s82, s82, 1
    s_add_u32 s33, s33, s58
    v_mov_b32 v17, v19
    v_mov_b32 v18, 0
    v_mov_b32 v160, 0
    v_mov_b32 v161, 0
    v_mov_b32 v162, 0
    v_mov_b32 v163, 0
    v_mov_b32 v164, 0
    v_mov_b32 v165, 0
    v_mov_b32 v166, 0
    v_mov_b32 v167, 0
    s_add_u32 s90, s58, 128
    s_mov_b32 s64, 1
    s_mov_b32 s88, 0
L_cchunk:
    s_lshl_b32 s74, s90, 2
    s_lshr_b32 s76, s54, 1
    s_add_u32 s74, s74, s76
    s_lshl_b32 s76, s74, 11
    s_lshl_b32 s74, s74, 7
    s_add_u32 s74, s74, 8388608
    v_and_b32 v20, 15, v0
    v_cmp_gt_u32 vcc, s64, v20
    v_mov_b32 v21, 1610612736
    s_nop 0
    v_cndmask_b32 v21, v21, v33, vcc
    buffer_load_dwordx2 v[24:25], v21, s[16:19], s74 offen sc1
    s_cmp_gt_u32 s64, 0
    s_cselect_b32 s77, s76, 1610612736
    buffer_load_dwordx4 v[40:43], v6, s[16:19], s77 offen sc1
    buffer_load_dwordx4 v[44:47], v6, s[16:19], s77 offen offset:512 sc1
    s_add_u32 s76, s76, 8192
    s_cmp_gt_u32 s64, 1
    s_cselect_b32 s77, s76, 1610612736
    buffer_load_dwordx4 v[48:51], v6, s[16:19], s77 offen sc1
    buffer_load_dwordx4 v[52:55], v6, s[16:19], s77 offen offset:512 sc1
    s_add_u32 s76, s76, 8192
    s_cmp_gt_u32 s64, 2
    s_cselect_b32 s77, s76, 1610612736
    buffer_load_dwordx4 v[56:59], v6, s[16:19], s77 offen sc1
    buffer_load_dwordx4 v[60:63], v6, s[16:19], s77 offen offset:512 sc1
    s_add_u32 s76, s76, 8192
    s_cmp_gt_u32 s64, 3
    s_cselect_b32 s77, s76, 1610612736
    buffer_load_dwordx4 v[64:67], v6, s[16:19], s77 offen sc1
    buffer_load_dwordx4 v[68:71], v6, s[16:19], s77 offen offset:512 sc1
    s_add_u32 s76, s76, 8192
    s_cmp_gt_u32 s64, 4
    s_cselect_b32 s77, s76, 1610612736
    buffer_load_dwordx4 v[72:75], v6, s[16:19], s77 offen sc1
    buffer_load_dwordx4 v[76:79], v6, s[16:19], s77 offen offset:512 sc1
    s_add_u32 s76, s76, 8192
    s_cmp_gt_u32 s64, 5
    s_cselect_b32 s77, s76, 1610612736
    buffer_load_dwordx4 v[80:83], v6, s[16:19], s77 offen sc1
    buffer_load_dwordx4 v[84:87], v6, s[16:19], s77 offen offset:512 sc1
    s_add_u32 s76, s76, 8192
    s_cmp_gt_u32 s64, 6
    s_cselect_b32 s77, s76, 1610612736
    buffer_load_dwordx4 v[88:91], v6, s[16:19], s77 offen sc1
    buffer_load_dwordx4 v[92:95], v6, s[16:19], s77 offen offset:512 sc1
    s_add_u32 s76, s76, 8192
    s_cmp_gt_u32 s64, 7
    s_cselect_b32 s77, s76, 1610612736
    buffer_load_dwordx4 v[96:99], v6, s[16:19], s77 offen sc1
    buffer_load_dwordx4 v[100:103], v6, s[16:19], s77 offen offset:512 sc1
    s_add_u32 s76, s76, 8192
    s_cmp_gt_u32 s64, 8
    s_cselect_b32 s77, s76, 1610612736
    buffer_load_dwordx4 v[104:107], v6, s[16:19], s77 offen sc1
    buffer_load_dwordx4 v[108:111], v6, s[16:19], s77 offen offset:512 sc1
    s_add_u32 s76, s76, 8192
    s_cmp_gt_u32 s64, 9
    s_cselect_b32 s77, s76, 1610612736
    buffer_load_dwordx4 v[112:115], v6, s[16:19], s77 offen sc1
    buffer_load_dwordx4 v[116:119], v6, s[16:19], s77 offen offset:512 sc1
    s_add_u32 s76, s76, 8192
    s_cmp_gt_u32 s64, 10
    s_cselect_b32 s77, s76, 1610612736
    buffer_load_dwordx4 v[120:123], v6, s[16:19], s77 offen sc1
    buffer_load_dwordx4 v[124:127], v6, s[16:19], s77 offen offset:512 sc1
    s_add_u32 s76, s76, 8192
    s_cmp_gt_u32 s64, 11
    s_cselect_b32 s77, s76, 1610612736
    buffer_load_dwordx4 v[128:131], v6, s[16:19], s77 offen sc1
    buffer_load_dwordx4 v[132:135], v6, s[16:19], s77 offen offset:512 sc1
    s_add_u32 s76, s76, 8192
    s_cmp_gt_u32 s64, 12
    s_cselect_b32 s77, s76, 1610612736
    buffer_load_dwordx4 v[136:139], v6, s[16:19], s77 offen sc1
    buffer_load_dwordx4 v[140:143], v6, s[16:19], s77 offen offset:512 sc1
    s_add_u32 s76, s76, 8192
    s_cmp_gt_u32 s64, 13
    s_cselect_b32 s77, s76, 1610612736
    buffer_load_dwordx4 v[144:147], v6, s[16:19], s77 offen sc1
    buffer_load_dwordx4 v[148:151], v6, s[16:19], s77 offen offset:512 sc1
    s_add_u32 s76, s76, 8192
    s_cmp_gt_u32 s64, 14
    s_cselect_b32 s77, s76, 1610612736
    buffer_load_dwordx4 v[152:155], v6, s[16:19], s77 offen sc1
    buffer_load_dwordx4 v[156:159], v6, s[16:19], s77 offen offset:512 sc1
    s_add_u32 s76, s76, 8192
    s_waitcnt vmcnt(30)
    v_cndmask_b32 v24, v19, v24, vcc
    v_max_f32 v20, v24, v17
    s_nop 1
    v_max_f32_dpp v20, v20, v20 row_ror:1 row_mask:0xf bank_mask:0xf
    s_nop 1
    v_max_f32_dpp v20, v20, v20 row_ror:2 row_mask:0xf bank_mask:0xf
    s_nop 1
    v_max_f32_dpp v20, v20, v20 row_ror:4 row_mask:0xf bank_mask:0xf
    s_nop 1
    v_max_f32_dpp v20, v20, v20 row_ror:8 row_mask:0xf bank_mask:0xf
    v_sub_f32 v34, v24, v20
    v_sub_f32 v21, v17, v20
    v_exp_f32 v34, v34
    v_exp_f32 v21, v21
    v_mov_b32 v17, v20
    v_mul_f32 v22, v34, v25
    s_nop 1
    v_add_f32_dpp v22, v22, v22 row_ror:1 row_mask:0xf bank_mask:0xf
    s_nop 1
    v_add_f32_dpp v22, v22, v22 row_ror:2 row_mask:0xf bank_mask:0xf
    s_nop 1
    v_add_f32_dpp v22, v22, v22 row_ror:4 row_mask:0xf bank_mask:0xf
    s_nop 1
    v_add_f32_dpp v22, v22, v22 row_ror:8 row_mask:0xf bank_mask:0xf
    v_fma_f32 v18, v18, v21, v22
    v_mul_f32 v160, v160, v21
    v_mul_f32 v161, v161, v21
    v_mul_f32 v162, v162, v21
    v_mul_f32 v163, v163, v21
    v_mul_f32 v164, v164, v21
    v_mul_f32 v165, v165, v21
    v_mul_f32 v166, v166, v21
    v_mul_f32 v167, v167, v21
    s_waitcnt vmcnt(28)
    v_fmac_f32_dpp v160, v34, v40 row_newbcast:0 row_mask:0xf bank_mask:0xf
    v_fmac_f32_dpp v161, v34, v41 row_newbcast:0 row_mask:0xf bank_mask:0xf
    v_fmac_f32_dpp v162, v34, v42 row_newbcast:0 row_mask:0xf bank_mask:0xf
    v_fmac_f32_dpp v163, v34, v43 row_newbcast:0 row_mask:0xf bank_mask:0xf
    v_fmac_f32_dpp v164, v34, v44 row_newbcast:0 row_mask:0xf bank_mask:0xf
    v_fmac_f32_dpp v165, v34, v45 row_newbcast:0 row_mask:0xf bank_mask:0xf
    v_fmac_f32_dpp v166, v34, v46 row_newbcast:0 row_mask:0xf bank_mask:0xf
    v_fmac_f32_dpp v167, v34, v47 row_newbcast:0 row_mask:0xf bank_mask:0xf
    s_waitcnt vmcnt(26)
    v_fmac_f32_dpp v160, v34, v48 row_newbcast:1 row_mask:0xf bank_mask:0xf
    v_fmac_f32_dpp v161, v34, v49 row_newbcast:1 row_mask:0xf bank_mask:0xf
    v_fmac_f32_dpp v162, v34, v50 row_newbcast:1 row_mask:0xf bank_mask:0xf
    v_fmac_f32_dpp v163, v34, v51 row_newbcast:1 row_mask:0xf bank_mask:0xf
    v_fmac_f32_dpp v164, v34, v52 row_newbcast:1 row_mask:0xf bank_mask:0xf
    v_fmac_f32_dpp v165, v34, v53 row_newbcast:1 row_mask:0xf bank_mask:0xf
    v_fmac_f32_dpp v166, v34, v54 row_newbcast:1 row_mask:0xf bank_mask:0xf
    v_fmac_f32_dpp v167, v34, v55 row_newbcast:1 row_mask:0xf bank_mask:0xf
    s_waitcnt vmcnt(24)
    v_fmac_f32_dpp v160, v34, v56 row_newbcast:2 row_mask:0xf bank_mask:0xf
    v_fmac_f32_dpp v161, v34, v57 row_newbcast:2 row_mask:0xf bank_mask:0xf
    v_fmac_f32_dpp v162, v34, v58 row_newbcast:2 row_mask:0xf bank_mask:0xf
    v_fmac_f32_dpp v163, v34, v59 row_newbcast:2 row_mask:0xf bank_mask:0xf
    v_fmac_f32_dpp v164, v34, v60 row_newbcast:2 row_mask:0xf bank_mask:0xf
    v_fmac_f32_dpp v165, v34, v61 row_newbcast:2 row_mask:0xf bank_mask:0xf
    v_fmac_f32_dpp v166, v34, v62 row_newbcast:2 row_mask:0xf bank_mask:0xf
    v_fmac_f32_dpp v167, v34, v63 row_newbcast:2 row_mask:0xf bank_mask:0xf
    s_waitcnt vmcnt(22)
    v_fmac_f32_dpp v160, v34, v64 row_newbcast:3 row_mask:0xf bank_mask:0xf
    v_fmac_f32_dpp v161, v34, v65 row_newbcast:3 row_mask:0xf bank_mask:0xf
    v_fmac_f32_dpp v162, v34, v66 row_newbcast:3 row_mask:0xf bank_mask:0xf
    v_fmac_f32_dpp v163, v34, v67 row_newbcast:3 row_mask:0xf bank_mask:0xf
    v_fmac_f32_dpp v164, v34, v68 row_newbcast:3 row_mask:0xf bank_mask:0xf
    v_fmac_f32_dpp v165, v34, v69 row_newbcast:3 row_mask:0xf bank_mask:0xf
    v_fmac_f32_dpp v166, v34, v70 row_newbcast:3 row_mask:0xf bank_mask:0xf
    v_fmac_f32_dpp v167, v34, v71 row_newbcast:3 row_mask:0xf bank_mask:0xf
    s_waitcnt vmcnt(20)
    v_fmac_f32_dpp v160, v34, v72 row_newbcast:4 row_mask:0xf bank_mask:0xf
    v_fmac_f32_dpp v161, v34, v73 row_newbcast:4 row_mask:0xf bank_mask:0xf
    v_fmac_f32_dpp v162, v34, v74 row_newbcast:4 row_mask:0xf bank_mask:0xf
    v_fmac_f32_dpp v163, v34, v75 row_newbcast:4 row_mask:0xf bank_mask:0xf
    v_fmac_f32_dpp v164, v34, v76 row_newbcast:4 row_mask:0xf bank_mask:0xf
    v_fmac_f32_dpp v165, v34, v77 row_newbcast:4 row_mask:0xf bank_mask:0xf
    v_fmac_f32_dpp v166, v34, v78 row_newbcast:4 row_mask:0xf bank_mask:0xf
    v_fmac_f32_dpp v167, v34, v79 row_newbcast:4 row_mask:0xf bank_mask:0xf
    s_waitcnt vmcnt(18)
    v_fmac_f32_dpp v160, v34, v80 row_newbcast:5 row_mask:0xf bank_mask:0xf
    v_fmac_f32_dpp v161, v34, v81 row_newbcast:5 row_mask:0xf bank_mask:0xf
    v_fmac_f32_dpp v162, v34, v82 row_newbcast:5 row_mask:0xf bank_mask:0xf
    v_fmac_f32_dpp v163, v34, v83 row_newbcast:5 row_mask:0xf bank_mask:0xf
    v_fmac_f32_dpp v164, v34, v84 row_newbcast:5 row_mask:0xf bank_mask:0xf
    v_fmac_f32_dpp v165, v34, v85 row_newbcast:5 row_mask:0xf bank_mask:0xf
    v_fmac_f32_dpp v166, v34, v86 row_newbcast:5 row_mask:0xf bank_mask:0xf
    v_fmac_f32_dpp v167, v34, v87 row_newbcast:5 row_mask:0xf bank_mask:0xf
    s_waitcnt vmcnt(16)
    v_fmac_f32_dpp v160, v34, v88 row_newbcast:6 row_mask:0xf bank_mask:0xf
    v_fmac_f32_dpp v161, v34, v89 row_newbcast:6 row_mask:0xf bank_mask:0xf
    v_fmac_f32_dpp v162, v34, v90 row_newbcast:6 row_mask:0xf bank_mask:0xf
    v_fmac_f32_dpp v163, v34, v91 row_newbcast:6 row_mask:0xf bank_mask:0xf
    v_fmac_f32_dpp v164, v34, v92 row_newbcast:6 row_mask:0xf bank_mask:0xf
    v_fmac_f32_dpp v165, v34, v93 row_newbcast:6 row_mask:0xf bank_mask:0xf
    v_fmac_f32_dpp v166, v34, v94 row_newbcast:6 row_mask:0xf bank_mask:0xf
    v_fmac_f32_dpp v167, v34, v95 row_newbcast:6 row_mask:0xf bank_mask:0xf
    s_waitcnt vmcnt(14)
    v_fmac_f32_dpp v160, v34, v96 row_newbcast:7 row_mask:0xf bank_mask:0xf
    v_fmac_f32_dpp v161, v34, v97 row_newbcast:7 row_mask:0xf bank_mask:0xf
    v_fmac_f32_dpp v162, v34, v98 row_newbcast:7 row_mask:0xf bank_mask:0xf
    v_fmac_f32_dpp v163, v34, v99 row_newbcast:7 row_mask:0xf bank_mask:0xf
    v_fmac_f32_dpp v164, v34, v100 row_newbcast:7 row_mask:0xf bank_mask:0xf
    v_fmac_f32_dpp v165, v34, v101 row_newbcast:7 row_mask:0xf bank_mask:0xf
    v_fmac_f32_dpp v166, v34, v102 row_newbcast:7 row_mask:0xf bank_mask:0xf
    v_fmac_f32_dpp v167, v34, v103 row_newbcast:7 row_mask:0xf bank_mask:0xf
    s_waitcnt vmcnt(12)
    v_fmac_f32_dpp v160, v34, v104 row_newbcast:8 row_mask:0xf bank_mask:0xf
    v_fmac_f32_dpp v161, v34, v105 row_newbcast:8 row_mask:0xf bank_mask:0xf
    v_fmac_f32_dpp v162, v34, v106 row_newbcast:8 row_mask:0xf bank_mask:0xf
    v_fmac_f32_dpp v163, v34, v107 row_newbcast:8 row_mask:0xf bank_mask:0xf
    v_fmac_f32_dpp v164, v34, v108 row_newbcast:8 row_mask:0xf bank_mask:0xf
    v_fmac_f32_dpp v165, v34, v109 row_newbcast:8 row_mask:0xf bank_mask:0xf
    v_fmac_f32_dpp v166, v34, v110 row_newbcast:8 row_mask:0xf bank_mask:0xf
    v_fmac_f32_dpp v167, v34, v111 row_newbcast:8 row_mask:0xf bank_mask:0xf
    s_waitcnt vmcnt(10)
    v_fmac_f32_dpp v160, v34, v112 row_newbcast:9 row_mask:0xf bank_mask:0xf
    v_fmac_f32_dpp v161, v34, v113 row_newbcast:9 row_mask:0xf bank_mask:0xf
    v_fmac_f32_dpp v162, v34, v114 row_newbcast:9 row_mask:0xf bank_mask:0xf
    v_fmac_f32_dpp v163, v34, v115 row_newbcast:9 row_mask:0xf bank_mask:0xf
    v_fmac_f32_dpp v164, v34, v116 row_newbcast:9 row_mask:0xf bank_mask:0xf
    v_fmac_f32_dpp v165, v34, v117 row_newbcast:9 row_mask:0xf bank_mask:0xf
    v_fmac_f32_dpp v166, v34, v118 row_newbcast:9 row_mask:0xf bank_mask:0xf
    v_fmac_f32_dpp v167, v34, v119 row_newbcast:9 row_mask:0xf bank_mask:0xf
    s_waitcnt vmcnt(8)
    v_fmac_f32_dpp v160, v34, v120 row_newbcast:10 row_mask:0xf bank_mask:0xf
    v_fmac_f32_dpp v161, v34, v121 row_newbcast:10 row_mask:0xf bank_mask:0xf
    v_fmac_f32_dpp v162, v34, v122 row_newbcast:10 row_mask:0xf bank_mask:0xf
    v_fmac_f32_dpp v163, v34, v123 row_newbcast:10 row_mask:0xf bank_mask:0xf
    v_fmac_f32_dpp v164, v34, v124 row_newbcast:10 row_mask:0xf bank_mask:0xf
    v_fmac_f32_dpp v165, v34, v125 row_newbcast:10 row_mask:0xf bank_mask:0xf
    v_fmac_f32_dpp v166, v34, v126 row_newbcast:10 row_mask:0xf bank_mask:0xf
    v_fmac_f32_dpp v167, v34, v127 row_newbcast:10 row_mask:0xf bank_mask:0xf
    s_waitcnt vmcnt(6)
    v_fmac_f32_dpp v160, v34, v128 row_newbcast:11 row_mask:0xf bank_mask:0xf
    v_fmac_f32_dpp v161, v34, v129 row_newbcast:11 row_mask:0xf bank_mask:0xf
    v_fmac_f32_dpp v162, v34, v130 row_newbcast:11 row_mask:0xf bank_mask:0xf
    v_fmac_f32_dpp v163, v34, v131 row_newbcast:11 row_mask:0xf bank_mask:0xf
    v_fmac_f32_dpp v164, v34, v132 row_newbcast:11 row_mask:0xf bank_mask:0xf
    v_fmac_f32_dpp v165, v34, v133 row_newbcast:11 row_mask:0xf bank_mask:0xf
    v_fmac_f32_dpp v166, v34, v134 row_newbcast:11 row_mask:0xf bank_mask:0xf
    v_fmac_f32_dpp v167, v34, v135 row_newbcast:11 row_mask:0xf bank_mask:0xf
    s_waitcnt vmcnt(4)
    v_fmac_f32_dpp v160, v34, v136 row_newbcast:12 row_mask:0xf bank_mask:0xf
    v_fmac_f32_dpp v161, v34, v137 row_newbcast:12 row_mask:0xf bank_mask:0xf
    v_fmac_f32_dpp v162, v34, v138 row_newbcast:12 row_mask:0xf bank_mask:0xf
    v_fmac_f32_dpp v163, v34, v139 row_newbcast:12 row_mask:0xf bank_mask:0xf
    v_fmac_f32_dpp v164, v34, v140 row_newbcast:12 row_mask:0xf bank_mask:0xf
    v_fmac_f32_dpp v165, v34, v141 row_newbcast:12 row_mask:0xf bank_mask:0xf
    v_fmac_f32_dpp v166, v34, v142 row_newbcast:12 row_mask:0xf bank_mask:0xf
    v_fmac_f32_dpp v167, v34, v143 row_newbcast:12 row_mask:0xf bank_mask:0xf
    s_waitcnt vmcnt(2)
    v_fmac_f32_dpp v160, v34, v144 row_newbcast:13 row_mask:0xf bank_mask:0xf
    v_fmac_f32_dpp v161, v34, v145 row_newbcast:13 row_mask:0xf bank_mask:0xf
    v_fmac_f32_dpp v162, v34, v146 row_newbcast:13 row_mask:0xf bank_mask:0xf
    v_fmac_f32_dpp v163, v34, v147 row_newbcast:13 row_mask:0xf bank_mask:0xf
    v_fmac_f32_dpp v164, v34, v148 row_newbcast:13 row_mask:0xf bank_mask:0xf
    v_fmac_f32_dpp v165, v34, v149 row_newbcast:13 row_mask:0xf bank_mask:0xf
    v_fmac_f32_dpp v166, v34, v150 row_newbcast:13 row_mask:0xf bank_mask:0xf
    v_fmac_f32_dpp v167, v34, v151 row_newbcast:13 row_mask:0xf bank_mask:0xf
    s_waitcnt vmcnt(0)
    v_fmac_f32_dpp v160, v34, v152 row_newbcast:14 row_mask:0xf bank_mask:0xf
    v_fmac_f32_dpp v161, v34, v153 row_newbcast:14 row_mask:0xf bank_mask:0xf
    v_fmac_f32_dpp v162, v34, v154 row_newbcast:14 row_mask:0xf bank_mask:0xf
    v_fmac_f32_dpp v163, v34, v155 row_newbcast:14 row_mask:0xf bank_mask:0xf
    v_fmac_f32_dpp v164, v34, v156 row_newbcast:14 row_mask:0xf bank_mask:0xf
    v_fmac_f32_dpp v165, v34, v157 row_newbcast:14 row_mask:0xf bank_mask:0xf
    v_fmac_f32_dpp v166, v34, v158 row_newbcast:14 row_mask:0xf bank_mask:0xf
    v_fmac_f32_dpp v167, v34, v159 row_newbcast:14 row_mask:0xf bank_mask:0xf
    s_add_u32 s90, s33, s88
    s_sub_u32 s64, s82, s88
    s_min_u32 s64, s64, 15
    s_mov_b32 s74, s88
    s_add_u32 s88, s88, 15
    s_cmp_lt_u32 s74, s82
    s_cbranch_scc1 L_cchunk
    v_rcp_f32 v20, v18
    s_and_b32 s74, s58, 31
    s_lshl_b32 s74, s74, 13
    s_lshl_b32 s75, s60, 10
    s_add_u32 s74, s74, s75
    v_mul_f32 v160, v160, v20
    v_mul_f32 v161, v161, v20
    v_mul_f32 v162, v162, v20
    v_mul_f32 v163, v163, v20
    v_mul_f32 v164, v164, v20
    v_mul_f32 v165, v165, v20
    v_mul_f32 v166, v166, v20
    v_mul_f32 v167, v167, v20
    v_cvt_pk_bf16_f32 v24, v160, v161
    v_cvt_pk_bf16_f32 v25, v162, v163
    v_cvt_pk_bf16_f32 v26, v164, v165
    v_cvt_pk_bf16_f32 v27, v166, v167
    buffer_store_dwordx4 v[24:27], v32, s[24:27], s74 offen
    s_branch L_chk
L_fin:
L_end:
    s_endpgm
.section .rodata,"a"
.p2align 6
.amdhsa_kernel standalone__paged_block_table_kv_pagedattention__sampling_kernel
  .amdhsa_next_free_vgpr 202
  .amdhsa_next_free_sgpr 102
  .amdhsa_accum_offset 204
  .amdhsa_group_segment_fixed_size 0
  .amdhsa_kernarg_size 64
  .amdhsa_user_sgpr_count 2
  .amdhsa_user_sgpr_kernarg_segment_ptr 1
  .amdhsa_system_sgpr_workgroup_id_x 1
.end_amdhsa_kernel
```
